```python
import torch

def _softmax(x, axis=-1):
    return torch.softmax(x, dim=axis)
def _gelu(x):
    return torch.nn.functional.gelu(x, approximate="tanh")
def _silu(x):
    return torch.nn.functional.silu(x)
def _sigmoid(x):
    return torch.sigmoid(x)
def _layernorm(x, axis=-1, eps=1e-5):
    m = x.mean(dim=axis, keepdim=True)
    v = x.var(dim=axis, keepdim=True, unbiased=False)
    return (x - m) / torch.sqrt(v + eps)
def _scatter_add(tgt, idx, src, axis=0):
    return tgt.clone().index_add_(axis, idx, src)
def _segment_sum(src, seg, n):
    out = torch.zeros((n,) + src.shape[1:], dtype=src.dtype)
    return out.index_add_(0, seg, src)
def _pad(x, pw):
    flat = tuple(v for pair in reversed(pw) for v in pair)
    return torch.nn.functional.pad(x, flat)

kernel_name = 'gated_mix__ssm_conv_s4d__moe_arch_mod__prompt'

def setup_inputs():

    _w = (lambda a: (lambda t: t.to(torch.bfloat16) if t.is_floating_point() else t)(torch.as_tensor(a)))
    def _A_setup():
        Bsz, L, D, N = 1, 2048, 1024, 128
        return {
            "u": _w((lambda *s: torch.randn(*s, dtype=torch.bfloat16) * 0.05)(Bsz, L, D)),
            "log_A_real": _w((lambda *s: torch.randn(*s, dtype=torch.bfloat16) * 6.4)(D, N) * 0.5),
            "A_imag": _w((lambda *s: torch.randn(*s, dtype=torch.bfloat16) * 0.1)(D, N) * 3.14),
            "C_real": _w((lambda *s: torch.randn(*s, dtype=torch.bfloat16) * 0.4)(D, N) / N ** 0.5),
            "C_imag": _w((lambda *s: torch.randn(*s, dtype=torch.bfloat16) * 0.4)(D, N) / N ** 0.5),
            "log_dt": _w((lambda *s: torch.randn(*s, dtype=torch.bfloat16) * 0.1)(D) * 0.5 - 4.0),
            "D_skip": _w((lambda *s: torch.randn(*s, dtype=torch.bfloat16) * 0.1)(D)),
        }
    _A_in = _A_setup()

    def _B_setup():
        B, S, D, F, C = 1, 2048, 1024, 3584, 8
        return {
            "x": _w((lambda *s: torch.randn(*s, dtype=torch.bfloat16) * 0.05)(B, S, D)),
            "w_r": _w((lambda *s: torch.randn(*s, dtype=torch.bfloat16) * 6.4)(D)),
            "w_gate": _w((lambda *s: torch.randn(*s, dtype=torch.bfloat16) * 0.1)(D, F)),
            "w_up": _w((lambda *s: torch.randn(*s, dtype=torch.bfloat16) * 0.1)(D, F)),
            "w_down": _w((lambda *s: torch.randn(*s, dtype=torch.bfloat16) * 0.1)(F, D)),
        }
    _B_in = _B_setup()

    return {
        "A_u": _A_in["u"],
        "A_log_A_real": _A_in["log_A_real"],
        "A_A_imag": _A_in["A_imag"],
        "A_C_real": _A_in["C_real"],
        "A_C_imag": _A_in["C_imag"],
        "A_log_dt": _A_in["log_dt"],
        "A_D_skip": _A_in["D_skip"],
        "B_x": _B_in["x"],
        "B_w_r": _B_in["w_r"],
        "B_w_gate": _B_in["w_gate"],
        "B_w_up": _B_in["w_up"],
        "B_w_down": _B_in["w_down"],
        "gate_w": _w((lambda *s: torch.randn(*s, dtype=torch.bfloat16) * 0.05)(1024) * 16.0),
    }

def reference(A_u, A_log_A_real, A_A_imag, A_C_real, A_C_imag, A_log_dt, A_D_skip, B_x, B_w_r, B_w_gate, B_w_up, B_w_down, gate_w):
    def _A_ref(u, log_A_real, A_imag, C_real, C_imag, log_dt, D_skip):
        L = u.shape[1]
        dt = torch.exp(log_dt)
        A = -torch.exp(log_A_real) + 1j * A_imag
        C = (C_real + 1j * C_imag) * dt[:, None]
        pos = (lambda x, dt: x.to(dt))(torch.arange(L), log_dt.dtype)
        P = torch.exp((A * dt[:, None])[:, :, None] * pos[None, None, :])
        K = 2.0 * torch.einsum("dn,dnl->dl", C, P).real
        L2 = 2 * L
        u_t = (lambda x, *d: x.permute(*d))(u, 0, 2, 1)
        Kf = (lambda x, *a, **k: torch.fft.rfft(x.float(), *a, **k))(K, L2)
        Uf = (lambda x, *a, **k: torch.fft.rfft(x.float(), *a, **k))(u_t, L2)
        y = (lambda x, *a, **k: torch.fft.irfft(x, *a, **k).to(torch.bfloat16))(Uf * Kf[None, :, :], L2)[:, :, :L]
        y = (lambda x, *d: x.permute(*d))(y, 0, 2, 1)
        return y + u * D_skip[None, None, :]

    def _B_ref(x, w_r, w_gate, w_up, w_down):
        B, S, D = x.shape
        C = 8
        r = x @ w_r
        idx = torch.argsort(-r, axis=-1)[:, :C]
        idx_e = (lambda x, n, axis: torch.repeat_interleave(x, n, dim=axis))(idx.reshape(B, C, 1), D, axis=2)
        x_sel = (lambda x, i, axis: torch.take_along_dim(x, i, dim=axis))(x, idx_e, axis=1)
        g = _silu(x_sel @ w_gate)
        u = x_sel @ w_up
        y = (g * u) @ w_down
        r_sel = _sigmoid((lambda x, i, axis: torch.take_along_dim(x, i, dim=axis))(r, idx, axis=1))
        y = y * r_sel.reshape(B, C, 1)
        b_off = (torch.arange(B) * S).reshape(B, 1)
        flat_idx = (idx + b_off).reshape(B * C)
        zero = (x * 0.0).reshape(B * S, D)
        upd = _scatter_add(zero, flat_idx, y.reshape(B * C, D), axis=0)
        return x + upd.reshape(B, S, D)

    x = A_u
    g = _sigmoid((x * gate_w).sum(-1, keepdims=True))
    a = _A_ref(x, A_log_A_real, A_A_imag, A_C_real, A_C_imag, A_log_dt, A_D_skip)
    b = _B_ref(x, B_w_r, B_w_gate, B_w_up, B_w_down)
    return g * a + (1 - g) * b
```

```asm
; @launch grid=(256,1,1) block=(512,1,1) lds=154624
.amdgcn_target "amdgcn-amd-amdhsa--gfx950"
.text
.globl gated_mix__ssm_conv_s4d__moe_arch_mod__prompt_kernel
.p2align 8
.type gated_mix__ssm_conv_s4d__moe_arch_mod__prompt_kernel,@function
gated_mix__ssm_conv_s4d__moe_arch_mod__prompt_kernel:
    s_cmp_ge_u32 s2, 256
    s_cbranch_scc1 L_END
    s_getpc_b64 s[48:49]
L_PC:
    s_lshr_b32 s40, s2, 3
    s_lshl_b32 s41, s40, 10
    v_lshl_add_u32 v9, v0, 1, s41
    v_min_u32 v9, L_END-L_PC, v9
    global_load_ushort v255, v9, s[48:49]
    s_load_dwordx8 s[16:23], s[0:1], 8
    s_load_dwordx4 s[24:27], s[0:1], 40
    s_load_dwordx2 s[4:5], s[0:1], 0
    s_load_dwordx2 s[8:9], s[0:1], 120
    s_load_dwordx8 s[28:35], s[0:1], 64
    s_load_dwordx2 s[36:37], s[0:1], 96
    s_load_dwordx2 s[12:13], s[0:1], 104
    v_readfirstlane_b32 s3, v0
    v_and_b32 v1, 63, v0
    v_mov_b32 v3, 0
    v_mov_b32 v2, 1
    v_lshlrev_b32 v8, 4, v1
    s_mov_b32 s6, 0x400000
    s_mov_b32 s7, 0x20000
    s_mov_b32 s10, 16777216
    s_mov_b32 s11, 0x20000
    s_mov_b32 s14, 0x400000
    s_mov_b32 s15, 0x20000
    s_lshr_b32 s3, s3, 6
    s_and_b32 s41, s2, 7
    s_lshr_b32 s40, s2, 4
    s_bfe_u32 s47, s2, 0x10003
    s_and_b32 s38, s3, 3
    s_cmp_ge_u32 s3, 4
    s_cbranch_scc1 L_N0
    s_xor_b32 s41, s41, s47
    s_lshl_b32 s39, s41, 4
    s_add_u32 s39, s39, s40
    s_lshl_b32 s41, s39, 1
    s_add_u32 s41, s41, s47
    s_lshl_b32 s41, s41, 2
    s_add_u32 s41, s41, s3
    s_lshl_b32 s42, s41, 8
    v_lshl_add_u32 v4, v1, 2, s42
    s_lshl_b32 s42, s41, 1
    v_mov_b32 v5, s42
    v_mov_b32 v12, 0
    v_mov_b32 v13, 0
    s_waitcnt lgkmcnt(0)
    global_load_short_d16_hi v12, v5, s[24:25]
    global_load_dword v8, v4, s[16:17]
    global_load_dword v9, v4, s[18:19]
    global_load_dword v10, v4, s[20:21]
    global_load_dword v11, v4, s[22:23]
    global_load_short_d16_hi v13, v5, s[26:27]
    s_barrier
    s_setprio 1
    s_branch L_S
L_N0:
    v_lshlrev_b32 v4, 2, v0
    v_and_b32 v4, 1023, v4
    ds_write_b32 v4, v3
    s_lshl_b32 s39, s41, 4
    s_add_u32 s39, s39, s40
    s_setprio 2
    s_lshl_b32 s41, s2, 14
    s_lshl_b32 s42, s38, 12
    s_add_u32 s41, s41, s42
    s_waitcnt lgkmcnt(0)
    s_cmp_lt_u32 s38, 2
    s_cselect_b32 s28, s28, s36
    s_cselect_b32 s29, s29, s37
    s_lshl_b32 s42, s38, 10
    s_add_u32 m0, s42, 141312
    s_and_b32 s42, s42, 1024
    v_add_u32 v9, s42, v8
    s_barrier
    buffer_load_dword v253, off, s[8:11], 0 sc1
    global_load_lds_dwordx4 v9, s[28:29]
    buffer_load_dwordx4 v[208:211], v8, s[4:7], s41 offen
    buffer_load_dwordx4 v[212:215], v8, s[4:7], s41 offen offset:1024
    buffer_load_dwordx4 v[216:219], v8, s[4:7], s41 offen offset:2048
    buffer_load_dwordx4 v[220:223], v8, s[4:7], s41 offen offset:3072
    s_mov_b64 exec, 1
    ds_add_u32 v3, v2 offset:52
    s_mov_b64 exec, -1
    s_cmp_lg_u32 s47, 0
    s_cbranch_scc1 L_M0
    v_and_b32 v168, 255, v0
    v_lshlrev_b32 v169, 14, v168
    s_lshl_b32 s43, s39, 4
    v_add_u32 v169, s43, v169
    s_movk_i32 s16, 0x1000
    s_movk_i32 s17, 0x2000
    s_movk_i32 s18, 0x3000
    s_and_b32 s19, s40, 7
    s_mov_b32 s62, 0
W_1:
    ds_read_b32 v10, v3 offset:52
    s_add_u32 s62, s62, 1
    s_waitcnt lgkmcnt(0)
    v_cmp_le_u32 vcc, 4, v10
    s_cbranch_vccnz WD_2
    s_sleep 1
    s_cmp_lt_u32 s62, 2097152
    s_cbranch_scc1 W_1
WD_2:
    s_cmp_lg_u32 s19, 0
    s_cbranch_scc1 U_3
    buffer_load_dwordx4 v[176:179], v169, s[4:7], 0 offen offset:0
U_3:
    s_cmp_lg_u32 s19, 1
    s_cbranch_scc1 U_4
    buffer_load_dwordx4 v[180:183], v169, s[4:7], 0 offen offset:2048
U_4:
    s_cmp_lg_u32 s19, 2
    s_cbranch_scc1 U_5
    buffer_load_dwordx4 v[184:187], v169, s[4:7], s16 offen offset:0
U_5:
    s_cmp_lg_u32 s19, 3
    s_cbranch_scc1 U_6
    buffer_load_dwordx4 v[188:191], v169, s[4:7], s16 offen offset:2048
U_6:
    s_cmp_lg_u32 s19, 4
    s_cbranch_scc1 U_7
    buffer_load_dwordx4 v[192:195], v169, s[4:7], s17 offen offset:0
U_7:
    s_cmp_lg_u32 s19, 5
    s_cbranch_scc1 U_8
    buffer_load_dwordx4 v[196:199], v169, s[4:7], s17 offen offset:2048
U_8:
    s_cmp_lg_u32 s19, 6
    s_cbranch_scc1 U_9
    buffer_load_dwordx4 v[200:203], v169, s[4:7], s18 offen offset:0
U_9:
    s_cmp_lg_u32 s19, 7
    s_cbranch_scc1 U_10
    buffer_load_dwordx4 v[204:207], v169, s[4:7], s18 offen offset:2048
U_10:
    s_branch L_S
L_M0:
    s_and_b32 s41, s2, 7
    s_lshl_b32 s39, s40, 3
    s_add_u32 s39, s39, s41
    s_lshr_b32 s41, s39, 1
    s_mul_i32 s42, s41, 37
    s_lshr_b32 s42, s42, 8
    s_mul_i32 s43, s42, 7
    s_sub_u32 s43, s41, s43
    s_lshl_b32 s51, s42, 3
    s_add_u32 s51, s51, s43
    s_cmp_ge_u32 s43, 3
    s_addc_u32 s51, s51, 0
    s_sub_u32 s41, s42, 7
    s_lshl_b32 s42, s43, 3
    s_add_u32 s42, s42, 3
    s_cmp_ge_u32 s39, 98
    s_cselect_b32 s51, s42, s51
    s_cselect_b32 s50, s41, 0
    s_cselect_b32 s63, 7, 8
    s_cselect_b32 s46, 0, 7340032
    s_mov_b32 s53, 408576
    s_cselect_b32 s53, 4294917120, s53
    s_mov_b32 s47, 0x20000
    s_mov_b32 s58, 7340032
    s_mov_b32 s59, 0x20000
    s_lshl_b32 s41, s38, s63
    s_lshl_b32 s42, s50, 9
    s_add_u32 s61, s41, s42
    s_mul_i32 s52, s61, 7168
    s_lshl_b32 s41, s51, 7
    s_add_u32 s52, s52, s41
    v_and_b32 v15, 7, v1
    v_lshrrev_b32 v16, 3, v1
    v_mul_u32_u24 v13, 57344, v16
    v_lshl_add_u32 v13, v15, 4, v13
    s_bitcmp1_b32 s39, 0
    s_cselect_b32 s56, s32, s30
    s_cselect_b32 s57, s33, s31
    s_mov_b32 s44, s56
    s_mov_b32 s45, s57
    s_cmp_ge_u32 s39, 126
    s_cselect_b32 s58, 0, s58
    s_mov_b32 s62, 0
W_11:
    ds_read_b32 v10, v3 offset:52
    s_add_u32 s62, s62, 1
    s_waitcnt lgkmcnt(0)
    v_cmp_le_u32 vcc, 4, v10
    s_cbranch_vccnz WD_12
    s_sleep 1
    s_cmp_lt_u32 s62, 2097152
    s_cbranch_scc1 W_11
WD_12:
    buffer_load_dwordx4 v[56:59], v13, s[56:59], s52 offen nt
    s_add_u32 s52, s52, 7168
    buffer_load_dwordx4 v[60:63], v13, s[56:59], s52 offen nt
    s_add_u32 s52, s52, 7168
    buffer_load_dwordx4 v[64:67], v13, s[56:59], s52 offen nt
    s_add_u32 s52, s52, 7168
    buffer_load_dwordx4 v[68:71], v13, s[56:59], s52 offen nt
    s_add_u32 s52, s52, 7168
    buffer_load_dwordx4 v[72:75], v13, s[56:59], s52 offen nt
    s_add_u32 s52, s52, 7168
    buffer_load_dwordx4 v[76:79], v13, s[56:59], s52 offen nt
    s_add_u32 s52, s52, 7168
    buffer_load_dwordx4 v[80:83], v13, s[56:59], s52 offen nt
    s_add_u32 s52, s52, 7168
    buffer_load_dwordx4 v[84:87], v13, s[56:59], s52 offen nt
    s_add_u32 s52, s52, 408576
    v_bfe_u32 v244, v1, 4, 1
    v_lshrrev_b32 v245, 5, v1
    v_lshlrev_b32 v244, 1, v244
    v_lshl_add_u32 v244, v245, 4, v244
    s_lshl_b32 s41, s38, 2
    v_add_u32 v244, s41, v244
    v_lshlrev_b32 v245, 2, v1
    v_lshrrev_b32 v246, 2, v1
    v_mul_u32_u24 v246, 8160, v246
    v_lshl_add_u32 v246, v1, 3, v246
    s_lshl_b32 s27, s2, 5
    s_add_u32 s27, s27, 4096
    v_add_u32 v247, 141312, v8
    s_waitcnt vmcnt(12)
    s_mov_b64 exec, 1
    ds_add_u32 v3, v2 offset:56
    s_mov_b64 exec, -1
    s_mov_b32 s62, 0
W_13:
    ds_read_b32 v10, v3 offset:56
    ds_read_b128 v[224:227], v247 offset:0
    ds_read_b128 v[228:231], v247 offset:1024
    ds_read_b128 v[232:235], v247 offset:2048
    ds_read_b128 v[236:239], v247 offset:3072
    s_add_u32 s62, s62, 1
    s_waitcnt lgkmcnt(0)
    v_cmp_le_u32 vcc, 4, v10
    s_cbranch_vccnz WD_14
    s_sleep 1
    s_cmp_lt_u32 s62, 2097152
    s_cbranch_scc1 W_13
WD_14:
    v_cmp_gt_u32 vcc, 32, v1
    s_waitcnt vmcnt(8)
    v_dot2_f32_bf16 v240, v208, v224, 0
    v_dot2_f32_bf16 v241, v216, v224, 0
    v_dot2_f32_bf16 v242, v208, v232, 0
    v_dot2_f32_bf16 v243, v216, v232, 0
    v_dot2_f32_bf16 v240, v209, v225, v240
    v_dot2_f32_bf16 v241, v217, v225, v241
    v_dot2_f32_bf16 v242, v209, v233, v242
    v_dot2_f32_bf16 v243, v217, v233, v243
    v_dot2_f32_bf16 v240, v210, v226, v240
    v_dot2_f32_bf16 v241, v218, v226, v241
    v_dot2_f32_bf16 v242, v210, v234, v242
    v_dot2_f32_bf16 v243, v218, v234, v243
    v_dot2_f32_bf16 v240, v211, v227, v240
    v_dot2_f32_bf16 v241, v219, v227, v241
    v_dot2_f32_bf16 v242, v211, v235, v242
    v_dot2_f32_bf16 v243, v219, v235, v243
    v_dot2_f32_bf16 v240, v212, v228, v240
    v_dot2_f32_bf16 v241, v220, v228, v241
    v_dot2_f32_bf16 v242, v212, v236, v242
    v_dot2_f32_bf16 v243, v220, v236, v243
    v_dot2_f32_bf16 v240, v213, v229, v240
    v_dot2_f32_bf16 v241, v221, v229, v241
    v_dot2_f32_bf16 v242, v213, v237, v242
    v_dot2_f32_bf16 v243, v221, v237, v243
    v_dot2_f32_bf16 v240, v214, v230, v240
    v_dot2_f32_bf16 v241, v222, v230, v241
    v_dot2_f32_bf16 v242, v214, v238, v242
    v_dot2_f32_bf16 v243, v222, v238, v243
    v_dot2_f32_bf16 v240, v215, v231, v240
    v_dot2_f32_bf16 v241, v223, v231, v241
    v_dot2_f32_bf16 v242, v215, v239, v242
    v_dot2_f32_bf16 v243, v223, v239, v243
    v_add_u32 v253, 2654435769, v253
    s_nop 0
    v_permlane32_swap_b32 v240, v242
    v_permlane32_swap_b32 v241, v243
    v_add_f32 v240, v240, v242
    v_add_f32 v241, v241, v243
    ds_write_b32 v3, v253 offset:32
    s_nop 0
    v_permlane16_swap_b32 v240, v241
    v_add_f32 v240, v240, v241
    s_nop 1
    v_add_f32_dpp v240, v240, v240 quad_perm:[1,0,3,2] row_mask:0xf bank_mask:0xf
    s_nop 1
    v_add_f32_dpp v240, v240, v240 quad_perm:[2,3,0,1] row_mask:0xf bank_mask:0xf
    s_nop 1
    v_add_f32_dpp v240, v240, v240 row_half_mirror row_mask:0xf bank_mask:0xf
    s_nop 1
    v_add_f32_dpp v240, v240, v240 row_mirror row_mask:0xf bank_mask:0xf
    v_cvt_pk_bf16_f32 v240, v240, v240
    v_and_b32 v241, 0xffff0000, v240
    v_mul_f32 v241, 0xbfb8aa3b, v241
    v_exp_f32 v241, v241
    v_ashrrev_i32 v242, 31, v240
    v_add_f32 v241, 1.0, v241
    v_rcp_f32 v241, v241
    v_or_b32 v242, 0x8000, v242
    v_xor_b32 v240, v240, v242
    v_cvt_pk_bf16_f32 v241, v241, 0
    v_cndmask_b32 v240, v241, v240, vcc
    ds_write_b16 v244, v240 offset:320
    s_mov_b64 exec, 1
    ds_add_rtn_u32 v10, v3, v2 offset:0
    s_mov_b64 exec, 0xff
    ds_read_b32 v252, v245 offset:320
    s_waitcnt lgkmcnt(0)
    v_readfirstlane_b32 s41, v10
    s_cmp_lg_u32 s41, 3
    s_cbranch_scc1 L_NPM
    buffer_store_dwordx2 v[252:253], v246, s[8:11], s27 offen sc1
    s_mov_b64 exec, 1
    ds_add_u32 v3, v2 offset:0
L_NPM:
    s_mov_b64 exec, -1
    s_cmp_ge_u32 s39, 126
    s_cbranch_scc1 L_AG
    s_setprio 0
    s_mov_b32 s62, 0
W_15:
    ds_read_b32 v10, v3 offset:0
    s_add_u32 s62, s62, 1
    s_waitcnt lgkmcnt(0)
    v_cmp_le_u32 vcc, 5, v10
    s_cbranch_vccnz WD_16
    s_sleep 1
    s_cmp_lt_u32 s62, 2097152
    s_cbranch_scc1 W_15
WD_16:
    buffer_load_dwordx4 v[88:91], v13, s[44:47], s52 offen nt
    s_add_u32 s52, s52, 7168
    buffer_load_dwordx4 v[92:95], v13, s[44:47], s52 offen nt
    s_add_u32 s52, s52, 7168
    s_waitcnt vmcnt(9)
    buffer_load_dwordx4 v[96:99], v13, s[44:47], s52 offen nt
    s_add_u32 s52, s52, 7168
    s_waitcnt vmcnt(9)
    buffer_load_dwordx4 v[100:103], v13, s[44:47], s52 offen nt
    s_add_u32 s52, s52, 7168
    s_waitcnt vmcnt(9)
    buffer_load_dwordx4 v[104:107], v13, s[44:47], s52 offen nt
    s_add_u32 s52, s52, 7168
    s_waitcnt vmcnt(9)
    buffer_load_dwordx4 v[108:111], v13, s[44:47], s52 offen nt
    s_add_u32 s52, s52, 7168
    s_waitcnt vmcnt(9)
    buffer_load_dwordx4 v[112:115], v13, s[44:47], s52 offen nt
    s_add_u32 s52, s52, 7168
    s_waitcnt vmcnt(9)
    buffer_load_dwordx4 v[116:119], v13, s[44:47], s52 offen nt
    s_add_u32 s52, s52, s53
    s_waitcnt vmcnt(9)
    buffer_load_dwordx4 v[120:123], v13, s[56:59], s52 offen nt
    s_add_u32 s52, s52, 7168
    s_waitcnt vmcnt(9)
    buffer_load_dwordx4 v[124:127], v13, s[56:59], s52 offen nt
    s_add_u32 s52, s52, 7168
    s_waitcnt vmcnt(9)
    buffer_load_dwordx4 v[128:131], v13, s[56:59], s52 offen nt
    s_add_u32 s52, s52, 7168
    s_waitcnt vmcnt(9)
    buffer_load_dwordx4 v[132:135], v13, s[56:59], s52 offen nt
    s_add_u32 s52, s52, 7168
    s_waitcnt vmcnt(9)
    buffer_load_dwordx4 v[136:139], v13, s[56:59], s52 offen nt
    s_add_u32 s52, s52, 7168
    s_waitcnt vmcnt(9)
    buffer_load_dwordx4 v[140:143], v13, s[56:59], s52 offen nt
    s_add_u32 s52, s52, 7168
    s_waitcnt vmcnt(9)
    buffer_load_dwordx4 v[144:147], v13, s[56:59], s52 offen nt
    s_add_u32 s52, s52, 7168
    s_waitcnt vmcnt(9)
    buffer_load_dwordx4 v[148:151], v13, s[56:59], s52 offen nt
    s_add_u32 s52, s52, 408576
    s_waitcnt vmcnt(9)
    buffer_load_dwordx4 v[152:155], v13, s[44:47], s52 offen nt
    s_add_u32 s52, s52, 7168
    s_waitcnt vmcnt(9)
    buffer_load_dwordx4 v[156:159], v13, s[44:47], s52 offen nt
    s_add_u32 s52, s52, 7168
    s_waitcnt vmcnt(9)
    buffer_load_dwordx4 v[160:163], v13, s[44:47], s52 offen nt
    s_add_u32 s52, s52, 7168
    s_waitcnt vmcnt(9)
    buffer_load_dwordx4 v[164:167], v13, s[44:47], s52 offen nt
    s_add_u32 s52, s52, 7168
    s_waitcnt vmcnt(9)
    buffer_load_dwordx4 v[168:171], v13, s[44:47], s52 offen nt
    s_add_u32 s52, s52, 7168
    s_waitcnt vmcnt(9)
    buffer_load_dwordx4 v[172:175], v13, s[44:47], s52 offen nt
    s_add_u32 s52, s52, 7168
    s_waitcnt vmcnt(9)
    buffer_load_dwordx4 v[176:179], v13, s[44:47], s52 offen nt
    s_add_u32 s52, s52, 7168
    s_waitcnt vmcnt(9)
    buffer_load_dwordx4 v[180:183], v13, s[44:47], s52 offen nt
    s_add_u32 s52, s52, 408576
    s_mov_b64 exec, 1
    ds_add_u32 v3, v2 offset:36
    s_mov_b64 exec, -1
    s_lshl_b32 s23, s61, 1
    s_add_u32 s23, s23, 36096
    s_lshl_b32 s24, 1, s63
    s_mov_b32 s54, 0x05040100
    s_mov_b32 s55, 0x07060302
    v_and_b32 v15, 7, v1
    v_lshrrev_b32 v12, 4, v1
    v_mul_u32_u24 v14, 8576, v12
    v_bfe_u32 v10, v1, 2, 2
    v_mul_u32_u24 v10, 1056, v10
    v_add_u32 v14, v14, v10
    v_and_b32 v10, 3, v1
    v_lshl_add_u32 v14, v10, 3, v14
    s_lshl_b32 s41, s3, 7
    s_add_u32 s41, s41, 71168
    v_add_u32 v14, s41, v14
    v_mul_u32_u24 v23, 160, v15
    v_lshl_add_u32 v23, v12, 4, v23
    v_add_u32 v23, 61440, v23
    v_mul_u32_u24 v19, 8320, v12
    v_lshl_add_u32 v19, v15, 4, v19
    s_and_b32 s60, s39, 1
    s_lshl_b32 s60, s60, 3
    s_add_u32 s60, s60, s3
    s_mul_i32 s61, s60, 133120
    s_lshl_b32 s41, s51, 7
    s_add_u32 s61, s61, s41
    s_add_u32 s61, s61, 1048576
    s_lshl_b32 s60, s60, 12
    s_mul_i32 s41, s51, 147
    s_lshr_b32 s41, s41, 11
    s_mul_i32 s41, s41, 72
    s_add_u32 s60, s60, s41
    s_lshl_b32 s41, s51, 2
    s_add_u32 s60, s60, s41
    s_add_u32 s60, s60, 589824
    v_lshlrev_b32 v11, 9, v1
    s_lshl_b32 s49, s51, 13
    s_add_u32 s49, s49, 65536
    v_and_b32 v18, 255, v0
    v_lshrrev_b32 v20, 5, v18
    v_and_b32 v21, 31, v18
    v_lshlrev_b32 v18, 3, v18
    s_mov_b32 s42, 0x00ff00ff
    s_mov_b32 s43, 0x00ff00ff
    s_mov_b32 s18, 0x07060501
    s_mov_b32 s19, 0x07060502
    s_mov_b32 s20, 0x07060503
    v_mul_u32_u24 v10, 2080, v15
    v_lshl_add_u32 v10, v16, 4, v10
    v_add_u32 v248, s23, v10
    v_add_u32 v250, s24, v248
    s_sub_u32 s24, s24, 128
    v_add_u32 v249, s24, v248
    v_add_u32 v251, s24, v250
    v_mul_u32_u24 v17, 272, v15
    v_lshl_add_u32 v17, v12, 4, v17
    s_mul_i32 s41, s38, 2176
    s_add_u32 s41, s41, 52736
    v_add_u32 v17, s41, v17
    v_and_b32 v10, 8, v1
    v_mul_u32_u24 v10, 11568, v10
    v_add_u32 v17, v17, v10
    v_mul_u32_u24 v22, 160, v20
    v_lshl_add_u32 v22, v21, 2, v22
    v_add_u32 v22, 61440, v22
    s_add_u32 s22, s49, 4096
    s_cmp_eq_u32 s63, 7
    s_cselect_b32 s22, s22, 16777216
    s_cselect_b32 s17, -1, 0
    v_and_b32 v254, s17, v253
    v_readfirstlane_b32 s26, v253
    s_mov_b32 s21, 0xffff0000
    s_lshl_b32 s41, s38, 9
    s_add_u32 s32, s49, s41
    s_add_u32 s32, s32, 508
    s_add_u32 s33, s32, 2048
    s_and_b32 s41, s17, 4096
    s_add_u32 s34, s32, s41
    s_add_u32 s35, s33, s41
    v_mul_u32_u24 v20, 272, v20
    v_lshl_add_u32 v21, v21, 3, v20
    v_add_u32 v21, 52736, v21
    s_and_b32 s41, s39, 1
    s_lshl_b32 s48, s50, 1
    s_add_u32 s48, s48, s41
    s_lshl_b32 s48, s48, 11
    s_add_u32 s48, s48, s49
    s_setprio 2
    v_perm_b32 v24, v60, v56, s54
    v_perm_b32 v28, v60, v56, s55
    v_perm_b32 v32, v61, v57, s54
    v_perm_b32 v36, v61, v57, s55
    v_perm_b32 v40, v62, v58, s54
    v_perm_b32 v44, v62, v58, s55
    v_perm_b32 v48, v63, v59, s54
    v_perm_b32 v52, v63, v59, s55
    v_perm_b32 v25, v68, v64, s54
    v_perm_b32 v29, v68, v64, s55
    v_perm_b32 v33, v69, v65, s54
    v_perm_b32 v37, v69, v65, s55
    v_perm_b32 v41, v70, v66, s54
    v_perm_b32 v45, v70, v66, s55
    v_perm_b32 v49, v71, v67, s54
    v_perm_b32 v53, v71, v67, s55
    v_perm_b32 v26, v76, v72, s54
    v_perm_b32 v30, v76, v72, s55
    v_perm_b32 v34, v77, v73, s54
    v_perm_b32 v38, v77, v73, s55
    v_perm_b32 v42, v78, v74, s54
    v_perm_b32 v46, v78, v74, s55
    v_perm_b32 v50, v79, v75, s54
    v_perm_b32 v54, v79, v75, s55
    v_perm_b32 v27, v84, v80, s54
    v_perm_b32 v31, v84, v80, s55
    v_perm_b32 v35, v85, v81, s54
    v_perm_b32 v39, v85, v81, s55
    v_perm_b32 v43, v86, v82, s54
    v_perm_b32 v47, v86, v82, s55
    v_perm_b32 v51, v87, v83, s54
    v_perm_b32 v55, v87, v83, s55
    v_perm_b32 v56, v92, v88, s54
    v_perm_b32 v60, v92, v88, s55
    v_perm_b32 v64, v93, v89, s54
    v_perm_b32 v68, v93, v89, s55
    v_perm_b32 v72, v94, v90, s54
    v_perm_b32 v76, v94, v90, s55
    v_perm_b32 v80, v95, v91, s54
    v_perm_b32 v84, v95, v91, s55
    v_perm_b32 v57, v100, v96, s54
    v_perm_b32 v61, v100, v96, s55
    v_perm_b32 v65, v101, v97, s54
    v_perm_b32 v69, v101, v97, s55
    v_perm_b32 v73, v102, v98, s54
    v_perm_b32 v77, v102, v98, s55
    v_perm_b32 v81, v103, v99, s54
    v_perm_b32 v85, v103, v99, s55
    v_perm_b32 v58, v108, v104, s54
    v_perm_b32 v62, v108, v104, s55
    v_perm_b32 v66, v109, v105, s54
    v_perm_b32 v70, v109, v105, s55
    v_perm_b32 v74, v110, v106, s54
    v_perm_b32 v78, v110, v106, s55
    v_perm_b32 v82, v111, v107, s54
    v_perm_b32 v86, v111, v107, s55
    v_perm_b32 v59, v116, v112, s54
    v_perm_b32 v63, v116, v112, s55
    v_perm_b32 v67, v117, v113, s54
    v_perm_b32 v71, v117, v113, s55
    v_perm_b32 v75, v118, v114, s54
    v_perm_b32 v79, v118, v114, s55
    v_perm_b32 v83, v119, v115, s54
    v_perm_b32 v87, v119, v115, s55
    v_perm_b32 v88, v124, v120, s54
    v_perm_b32 v92, v124, v120, s55
    v_perm_b32 v96, v125, v121, s54
    v_perm_b32 v100, v125, v121, s55
    v_perm_b32 v104, v126, v122, s54
    v_perm_b32 v108, v126, v122, s55
    v_perm_b32 v112, v127, v123, s54
    v_perm_b32 v116, v127, v123, s55
    v_perm_b32 v89, v132, v128, s54
    v_perm_b32 v93, v132, v128, s55
    v_perm_b32 v97, v133, v129, s54
    v_perm_b32 v101, v133, v129, s55
    v_perm_b32 v105, v134, v130, s54
    v_perm_b32 v109, v134, v130, s55
    v_perm_b32 v113, v135, v131, s54
    v_perm_b32 v117, v135, v131, s55
    v_perm_b32 v90, v140, v136, s54
    v_perm_b32 v94, v140, v136, s55
    v_perm_b32 v98, v141, v137, s54
    v_perm_b32 v102, v141, v137, s55
    v_perm_b32 v106, v142, v138, s54
    v_perm_b32 v110, v142, v138, s55
    v_perm_b32 v114, v143, v139, s54
    v_perm_b32 v118, v143, v139, s55
    s_waitcnt vmcnt(8)
    v_perm_b32 v91, v148, v144, s54
    v_perm_b32 v95, v148, v144, s55
    v_perm_b32 v99, v149, v145, s54
    v_perm_b32 v103, v149, v145, s55
    v_perm_b32 v107, v150, v146, s54
    v_perm_b32 v111, v150, v146, s55
    v_perm_b32 v115, v151, v147, s54
    v_perm_b32 v119, v151, v147, s55
    s_waitcnt vmcnt(6)
    v_perm_b32 v120, v156, v152, s54
    v_perm_b32 v124, v156, v152, s55
    v_perm_b32 v128, v157, v153, s54
    v_perm_b32 v132, v157, v153, s55
    v_perm_b32 v136, v158, v154, s54
    v_perm_b32 v140, v158, v154, s55
    v_perm_b32 v144, v159, v155, s54
    v_perm_b32 v148, v159, v155, s55
    s_waitcnt vmcnt(4)
    v_perm_b32 v121, v164, v160, s54
    v_perm_b32 v125, v164, v160, s55
    v_perm_b32 v129, v165, v161, s54
    v_perm_b32 v133, v165, v161, s55
    v_perm_b32 v137, v166, v162, s54
    v_perm_b32 v141, v166, v162, s55
    v_perm_b32 v145, v167, v163, s54
    v_perm_b32 v149, v167, v163, s55
    s_waitcnt vmcnt(2)
    v_perm_b32 v122, v172, v168, s54
    v_perm_b32 v126, v172, v168, s55
    v_perm_b32 v130, v173, v169, s54
    v_perm_b32 v134, v173, v169, s55
    v_perm_b32 v138, v174, v170, s54
    v_perm_b32 v142, v174, v170, s55
    v_perm_b32 v146, v175, v171, s54
    v_perm_b32 v150, v175, v171, s55
    s_waitcnt vmcnt(0)
    v_perm_b32 v123, v180, v176, s54
    v_perm_b32 v127, v180, v176, s55
    v_perm_b32 v131, v181, v177, s54
    v_perm_b32 v135, v181, v177, s55
    v_perm_b32 v139, v182, v178, s54
    v_perm_b32 v143, v182, v178, s55
    v_perm_b32 v147, v183, v179, s54
    v_perm_b32 v151, v183, v179, s55
    s_setprio 3
    s_mov_b32 s62, 0
W_17:
    ds_read_b32 v10, v3 offset:60
    ds_read_b128 v[216:219], v248
    ds_read_b128 v[220:223], v249
    ds_read_b128 v[224:227], v250
    ds_read_b128 v[228:231], v251
    s_add_u32 s62, s62, 1
    s_waitcnt lgkmcnt(0)
    v_cmp_le_u32 vcc, 4, v10
    s_cbranch_vccnz WD_18
    s_cmp_lt_u32 s62, 2097152
    s_cbranch_scc1 W_17
WD_18:
    s_waitcnt lgkmcnt(0)
    v_mfma_f32_16x16x32_bf16 v[184:187], v[24:27], v[216:219], 0
    v_mfma_f32_16x16x32_bf16 v[200:203], v[40:43], v[216:219], 0
    v_mfma_f32_16x16x32_bf16 v[184:187], v[56:59], v[220:223], v[184:187]
    v_mfma_f32_16x16x32_bf16 v[200:203], v[72:75], v[220:223], v[200:203]
    v_mfma_f32_16x16x32_bf16 v[184:187], v[88:91], v[224:227], v[184:187]
    v_mfma_f32_16x16x32_bf16 v[200:203], v[104:107], v[224:227], v[200:203]
    v_mfma_f32_16x16x32_bf16 v[184:187], v[120:123], v[228:231], v[184:187]
    v_mfma_f32_16x16x32_bf16 v[200:203], v[136:139], v[228:231], v[200:203]
    v_mfma_f32_16x16x32_bf16 v[188:191], v[28:31], v[216:219], 0
    v_mfma_f32_16x16x32_bf16 v[204:207], v[44:47], v[216:219], 0
    v_mfma_f32_16x16x32_bf16 v[188:191], v[60:63], v[220:223], v[188:191]
    v_mfma_f32_16x16x32_bf16 v[204:207], v[76:79], v[220:223], v[204:207]
    s_nop 3
    v_permlane32_swap_b32 v184, v200
    v_permlane32_swap_b32 v185, v201
    v_mfma_f32_16x16x32_bf16 v[188:191], v[92:95], v[224:227], v[188:191]
    v_permlane32_swap_b32 v186, v202
    v_permlane32_swap_b32 v187, v203
    v_mfma_f32_16x16x32_bf16 v[204:207], v[108:111], v[224:227], v[204:207]
    v_add_f32_dpp v184, v200, v184 row_ror:8 row_mask:0xf bank_mask:0xf
    v_add_f32_dpp v185, v201, v185 row_ror:8 row_mask:0xf bank_mask:0xf
    v_mfma_f32_16x16x32_bf16 v[188:191], v[124:127], v[228:231], v[188:191]
    v_add_f32_dpp v186, v202, v186 row_ror:8 row_mask:0xf bank_mask:0xf
    v_add_f32_dpp v187, v203, v187 row_ror:8 row_mask:0xf bank_mask:0xf
    v_mfma_f32_16x16x32_bf16 v[204:207], v[140:143], v[228:231], v[204:207]
    ds_write_b128 v17, v[184:187] offset:0
    v_mfma_f32_16x16x32_bf16 v[192:195], v[32:35], v[216:219], 0
    v_mfma_f32_16x16x32_bf16 v[208:211], v[48:51], v[216:219], 0
    v_mfma_f32_16x16x32_bf16 v[192:195], v[64:67], v[220:223], v[192:195]
    v_mfma_f32_16x16x32_bf16 v[208:211], v[80:83], v[220:223], v[208:211]
    s_nop 2
    v_permlane32_swap_b32 v188, v204
    v_permlane32_swap_b32 v189, v205
    v_mfma_f32_16x16x32_bf16 v[192:195], v[96:99], v[224:227], v[192:195]
    v_permlane32_swap_b32 v190, v206
    v_permlane32_swap_b32 v191, v207
    v_mfma_f32_16x16x32_bf16 v[208:211], v[112:115], v[224:227], v[208:211]
    v_add_f32_dpp v188, v204, v188 row_ror:8 row_mask:0xf bank_mask:0xf
    v_add_f32_dpp v189, v205, v189 row_ror:8 row_mask:0xf bank_mask:0xf
    v_mfma_f32_16x16x32_bf16 v[192:195], v[128:131], v[228:231], v[192:195]
    v_add_f32_dpp v190, v206, v190 row_ror:8 row_mask:0xf bank_mask:0xf
    v_add_f32_dpp v191, v207, v191 row_ror:8 row_mask:0xf bank_mask:0xf
    v_mfma_f32_16x16x32_bf16 v[208:211], v[144:147], v[228:231], v[208:211]
    ds_write_b128 v17, v[188:191] offset:64
    v_mfma_f32_16x16x32_bf16 v[196:199], v[36:39], v[216:219], 0
    v_mfma_f32_16x16x32_bf16 v[212:215], v[52:55], v[216:219], 0
    v_mfma_f32_16x16x32_bf16 v[196:199], v[68:71], v[220:223], v[196:199]
    v_mfma_f32_16x16x32_bf16 v[212:215], v[84:87], v[220:223], v[212:215]
    s_nop 2
    v_permlane32_swap_b32 v192, v208
    v_permlane32_swap_b32 v193, v209
    v_mfma_f32_16x16x32_bf16 v[196:199], v[100:103], v[224:227], v[196:199]
    v_permlane32_swap_b32 v194, v210
    v_permlane32_swap_b32 v195, v211
    v_mfma_f32_16x16x32_bf16 v[212:215], v[116:119], v[224:227], v[212:215]
    v_add_f32_dpp v192, v208, v192 row_ror:8 row_mask:0xf bank_mask:0xf
    v_add_f32_dpp v193, v209, v193 row_ror:8 row_mask:0xf bank_mask:0xf
    v_mfma_f32_16x16x32_bf16 v[196:199], v[132:135], v[228:231], v[196:199]
    v_add_f32_dpp v194, v210, v194 row_ror:8 row_mask:0xf bank_mask:0xf
    v_add_f32_dpp v195, v211, v195 row_ror:8 row_mask:0xf bank_mask:0xf
    v_mfma_f32_16x16x32_bf16 v[212:215], v[148:151], v[228:231], v[212:215]
    ds_write_b128 v17, v[192:195] offset:128
    s_nop 6
    v_permlane32_swap_b32 v196, v212
    v_permlane32_swap_b32 v197, v213
    v_permlane32_swap_b32 v198, v214
    v_permlane32_swap_b32 v199, v215
    v_add_f32_dpp v196, v212, v196 row_ror:8 row_mask:0xf bank_mask:0xf
    v_add_f32_dpp v197, v213, v197 row_ror:8 row_mask:0xf bank_mask:0xf
    v_add_f32_dpp v198, v214, v198 row_ror:8 row_mask:0xf bank_mask:0xf
    v_add_f32_dpp v199, v215, v199 row_ror:8 row_mask:0xf bank_mask:0xf
    ds_write_b128 v17, v[196:199] offset:192
    s_mov_b64 exec, 1
    ds_add_u32 v3, v2 offset:24
    s_mov_b64 exec, -1
    s_mov_b32 s62, 0
W_19:
    ds_read_b32 v10, v3 offset:24
    ds_read_b64 v[200:201], v21 offset:0
    ds_read_b64 v[202:203], v21 offset:2176
    ds_read_b64 v[204:205], v21 offset:4352
    ds_read_b64 v[206:207], v21 offset:6528
    s_add_u32 s62, s62, 1
    s_waitcnt lgkmcnt(0)
    v_cmp_le_u32 vcc, 4, v10
    s_cbranch_vccnz WD_20
    s_cmp_lt_u32 s62, 2097152
    s_cbranch_scc1 W_19
WD_20:
    v_pk_add_f32 v[200:201], v[200:201], v[202:203]
    v_pk_add_f32 v[204:205], v[204:205], v[206:207]
    v_pk_add_f32 v[200:201], v[200:201], v[204:205]
    v_cvt_pk_bf16_f32 v252, v200, v201
    buffer_store_dwordx2 v[252:253], v18, s[8:11], s48 offen sc1
    s_mov_b64 exec, 1
    ds_add_u32 v3, v2 offset:48
    s_mov_b64 exec, -1
    s_cmp_lg_u32 s50, 0
    s_cbranch_scc1 L_MEND
    s_waitcnt vmcnt(0)
    s_mov_b32 s63, 0
    buffer_load_dwordx2 v[120:121], v18, s[8:11], s49 offen sc1
    buffer_load_dwordx2 v[122:123], v18, s[8:11], s49 offen offset:2048 sc1
    buffer_load_dwordx2 v[124:125], v18, s[8:11], s22 offen sc1
    buffer_load_dwordx2 v[126:127], v18, s[8:11], s22 offen offset:2048 sc1
    s_mov_b64 exec, 1
    ds_add_u32 v3, v2 offset:12
    s_mov_b64 exec, -1
    s_mov_b32 s62, 0
W_24:
    ds_read_b32 v10, v3 offset:40
    s_add_u32 s62, s62, 1
    s_waitcnt lgkmcnt(0)
    v_cmp_le_u32 vcc, 4, v10
    s_cbranch_vccnz WD_25
    s_cmp_lt_u32 s62, 2097152
    s_cbranch_scc1 W_24
WD_25:
    ds_read_b64_tr_b16 v[56:57], v14 offset:0
    ds_read_b64_tr_b16 v[58:59], v14 offset:4224
    ds_read_b64_tr_b16 v[72:73], v14 offset:34304
    ds_read_b64_tr_b16 v[74:75], v14 offset:38528
    ds_read_b64_tr_b16 v[60:61], v14 offset:32
    ds_read_b64_tr_b16 v[62:63], v14 offset:4256
    ds_read_b64_tr_b16 v[76:77], v14 offset:34336
    ds_read_b64_tr_b16 v[78:79], v14 offset:38560
    ds_read_b64_tr_b16 v[64:65], v14 offset:64
    ds_read_b64_tr_b16 v[66:67], v14 offset:4288
    ds_read_b64_tr_b16 v[80:81], v14 offset:34368
    ds_read_b64_tr_b16 v[82:83], v14 offset:38592
    ds_read_b64_tr_b16 v[68:69], v14 offset:96
    ds_read_b64_tr_b16 v[70:71], v14 offset:4320
    ds_read_b64_tr_b16 v[84:85], v14 offset:34400
    ds_read_b64_tr_b16 v[86:87], v14 offset:38624
    v_mov_b32 v27, v253
    v_mov_b32 v31, v253
    v_mov_b32 v35, v253
    v_mov_b32 v39, v253
    s_waitcnt vmcnt(0)
    s_branch PC_23
P_21:
    buffer_load_dwordx2 v[120:121], v18, s[8:11], s49 offen sc1
    buffer_load_dwordx2 v[122:123], v18, s[8:11], s49 offen offset:2048 sc1
    buffer_load_dwordx2 v[124:125], v18, s[8:11], s22 offen sc1
    buffer_load_dwordx2 v[126:127], v18, s[8:11], s22 offen offset:2048 sc1
    s_waitcnt vmcnt(0)
PC_23:
    s_add_u32 s63, s63, 1
    v_xor_b32 v10, v253, v121
    v_bitop3_b32 v10, v123, v253, v10 bitop3:0xbe
    v_bitop3_b32 v10, v125, v254, v10 bitop3:0xbe
    v_bitop3_b32 v10, v127, v254, v10 bitop3:0xbe
    v_cmp_ne_u32 vcc, 0, v10
    v_lshlrev_b32 v128, 16, v120
    v_and_b32 v129, s21, v120
    v_lshlrev_b32 v130, 16, v122
    v_and_b32 v131, s21, v122
    v_lshlrev_b32 v132, 16, v124
    v_and_b32 v133, s21, v124
    v_lshlrev_b32 v134, 16, v126
    v_and_b32 v135, s21, v126
    s_cbranch_vccz PD_22
    s_cmp_lt_u32 s63, 32768
    s_cbranch_scc1 P_21
PD_22:
    v_pk_add_f32 v[128:129], v[128:129], v[132:133]
    v_pk_add_f32 v[130:131], v[130:131], v[134:135]
    v_mul_f32 v132, 0xbfb8aa3b, v128
    v_mul_f32 v133, 0xbfb8aa3b, v129
    v_exp_f32 v132, v132
    v_exp_f32 v133, v133
    v_pk_mul_f32 v[128:129], v[128:129], v[130:131]
    v_add_f32 v132, 1.0, v132
    v_add_f32 v133, 1.0, v133
    v_rcp_f32 v132, v132
    v_rcp_f32 v133, v133
    s_nop 0
    v_pk_mul_f32 v[128:129], v[128:129], v[132:133]
    v_cvt_pk_bf16_f32 v10, v128, v129
    ds_write_b32 v22, v10
    s_mov_b64 exec, 1
    ds_add_u32 v3, v2 offset:28
    s_mov_b64 exec, -1
L_FFN2:
    s_mov_b32 s62, 0
W_26:
    ds_read_b32 v10, v3 offset:28
    ds_read_b128 v[216:219], v23 offset:0
    ds_read_b128 v[220:223], v23 offset:64
    s_add_u32 s62, s62, 1
    s_waitcnt lgkmcnt(0)
    v_cmp_le_u32 vcc, 4, v10
    s_cbranch_vccnz WD_27
    s_cmp_lt_u32 s62, 2097152
    s_cbranch_scc1 W_26
WD_27:
    s_mov_b64 exec, 0xff
    buffer_store_dword v253, v11, s[8:11], s60 offen sc1
    s_mov_b64 exec, -1
    v_mfma_f32_16x16x32_bf16 v[88:91], v[56:59], v[216:219], 0
    v_mfma_f32_16x16x32_bf16 v[88:91], v[72:75], v[220:223], v[88:91]
    v_mfma_f32_16x16x32_bf16 v[92:95], v[60:63], v[216:219], 0
    v_mfma_f32_16x16x32_bf16 v[92:95], v[76:79], v[220:223], v[92:95]
    v_mfma_f32_16x16x32_bf16 v[96:99], v[64:67], v[216:219], 0
    v_mfma_f32_16x16x32_bf16 v[96:99], v[80:83], v[220:223], v[96:99]
    v_mfma_f32_16x16x32_bf16 v[100:103], v[68:71], v[216:219], 0
    v_mfma_f32_16x16x32_bf16 v[100:103], v[84:87], v[220:223], v[100:103]
    s_mov_b64 exec, s[42:43]
    s_nop 0
    v_perm_b32 v24, v88, v91, s18
    v_perm_b32 v25, v89, v91, s19
    v_perm_b32 v26, v90, v91, s20
    buffer_store_dwordx4 v[24:27], v19, s[8:11], s61 offen sc1
    s_add_u32 s61, s61, 33280
    v_perm_b32 v28, v92, v95, s18
    v_perm_b32 v29, v93, v95, s19
    v_perm_b32 v30, v94, v95, s20
    buffer_store_dwordx4 v[28:31], v19, s[8:11], s61 offen sc1
    s_add_u32 s61, s61, 33280
    v_perm_b32 v32, v96, v99, s18
    v_perm_b32 v33, v97, v99, s19
    v_perm_b32 v34, v98, v99, s20
    buffer_store_dwordx4 v[32:35], v19, s[8:11], s61 offen sc1
    s_add_u32 s61, s61, 33280
    v_perm_b32 v36, v100, v103, s18
    v_perm_b32 v37, v101, v103, s19
    v_perm_b32 v38, v102, v103, s20
    buffer_store_dwordx4 v[36:39], v19, s[8:11], s61 offen sc1
L_MEND:
    s_endpgm
L_AG:
    s_mov_b32 s21, 0xffff0000
    v_lshrrev_b32 v12, 4, v1
    s_lshl_b32 s41, s38, 11
    v_add_u32 v239, s41, v8
    v_lshrrev_b32 v240, 2, v239
    v_or_b32 v240, 0x8000, v240
    v_add_u32 v241, 1, v240
    v_add_u32 v242, 2, v240
    v_add_u32 v243, 3, v240
    v_add_u32 v244, 256, v240
    v_add_u32 v245, 257, v240
    v_add_u32 v246, 258, v240
    v_add_u32 v247, 259, v240
    s_lshl_b32 s41, s38, 4
    v_lshl_add_u32 v220, v12, 2, s41
    v_and_b32 v221, 15, v1
    v_lshlrev_b32 v221, 2, v221
    v_lshlrev_b32 v222, 4, v12
    s_lshl_b32 s26, s38, 5
    s_add_u32 s27, s26, 28
    v_and_b32 v223, 7, v1
    v_lshl_add_u32 v223, v223, 2, s26
    v_lshrrev_b32 v224, 3, v1
    v_lshlrev_b32 v224, 4, v224
    v_mov_b32 v225, 172
    v_mov_b32 v226, 44
    s_mov_b32 s25, 4096
    v_and_b32 v4, 3, v1
    v_lshlrev_b32 v5, 3, v4
    v_lshrrev_b32 v6, 2, v1
    v_lshlrev_b32 v6, 7, v6
    v_lshl_add_u32 v6, v4, 4, v6
    s_and_b32 s41, s39, 1
    s_lshl_b32 s41, s41, 2
    s_add_u32 s41, s41, s38
    s_lshl_b32 s19, s41, 11
    s_add_u32 s19, s19, 524288
    v_mov_b32 v25, v253
    v_mov_b32 v27, v253
    s_mov_b32 s62, 0
W_28:
    ds_read_b32 v10, v3 offset:4
    s_add_u32 s62, s62, 1
    s_waitcnt lgkmcnt(0)
    v_cmp_le_u32 vcc, 4, v10
    s_cbranch_vccnz WD_29
    s_sleep 2
    s_cmp_lt_u32 s62, 2097152
    s_cbranch_scc1 W_28
WD_29:
    s_mov_b64 s[44:45], -1
    s_mov_b64 s[46:47], -1
    s_mov_b32 s62, 0
L_RM:
    s_mov_b64 exec, s[44:45]
    s_cbranch_execz L_RM0
    buffer_load_dwordx4 v[192:195], v239, s[8:11], s25 offen sc1
L_RM0:
    s_mov_b64 exec, s[46:47]
    s_cbranch_execz L_RM1
    buffer_load_dwordx4 v[196:199], v239, s[8:11], s25 offen offset:1024 sc1
L_RM1:
    s_mov_b64 exec, -1
    s_add_u32 s62, s62, 1
    s_waitcnt vmcnt(0)
    v_xor_b32 v10, v253, v193
    v_xor_b32 v11, v253, v197
    v_bitop3_b32 v10, v195, v253, v10 bitop3:0xbe
    v_bitop3_b32 v11, v199, v253, v11 bitop3:0xbe
    v_cmp_ne_u32 s[44:45], 0, v10
    v_cmp_ne_u32 s[46:47], 0, v11
    v_lshl_or_b32 v200, v192, 16, v240
    v_and_or_b32 v201, v192, s21, v241
    v_lshl_or_b32 v202, v194, 16, v242
    v_and_or_b32 v203, v194, s21, v243
    v_lshl_or_b32 v204, v196, 16, v244
    v_and_or_b32 v205, v196, s21, v245
    v_lshl_or_b32 v206, v198, 16, v246
    v_and_or_b32 v207, v198, s21, v247
    s_or_b64 s[42:43], s[44:45], s[46:47]
    s_cbranch_scc0 L_RMD
    s_cmp_lt_u32 s62, 32768
    s_cbranch_scc1 L_RM
L_RMD:
    v_max3_u32 v212, v200, v201, v202
    v_max3_u32 v211, v203, v204, v205
    v_max3_u32 v210, v212, v206, v207
    v_max_u32 v210, v210, v211
    v_med3_u32 v213, v200, v201, v202
    v_min3_u32 v214, v200, v201, v202
    v_max_u32_dpp v210, v210, v210 quad_perm:[1,0,3,2] row_mask:0xf bank_mask:0xf
    v_med3_u32 v214, v213, v214, v203
    v_med3_u32 v213, v212, v213, v203
    v_max_u32_dpp v210, v210, v210 quad_perm:[2,3,0,1] row_mask:0xf bank_mask:0xf
    v_max_u32 v212, v212, v203
    v_med3_u32 v214, v213, v214, v204
    v_max_u32_dpp v210, v210, v210 row_half_mirror row_mask:0xf bank_mask:0xf
    v_med3_u32 v213, v212, v213, v204
    v_max_u32 v212, v212, v204
    v_max_u32_dpp v210, v210, v210 row_mirror row_mask:0xf bank_mask:0xf
    ds_write_b32 v220, v210 offset:64
    ds_read_b32 v215, v221 offset:64
    ds_read_b128 v[216:219], v222 offset:64
    v_med3_u32 v214, v213, v214, v205
    v_med3_u32 v213, v212, v213, v205
    v_max_u32 v212, v212, v205
    v_med3_u32 v214, v213, v214, v206
    v_med3_u32 v213, v212, v213, v206
    v_max_u32 v212, v212, v206
    v_med3_u32 v214, v213, v214, v207
    v_med3_u32 v213, v212, v213, v207
    v_max_u32 v212, v212, v207
    s_mov_b32 s62, 0
L_GMWG:
    s_waitcnt lgkmcnt(0)
    v_cmp_eq_u32 vcc, 0, v215
    v_cmp_gt_u32 s[28:29], v216, v215
    v_cmp_gt_u32 s[30:31], v217, v215
    v_cmp_gt_u32 s[32:33], v218, v215
    v_cmp_gt_u32 s[34:35], v219, v215
    v_addc_co_u32 v209, s[36:37], 0, v3, s[28:29]
    v_addc_co_u32 v209, s[36:37], 0, v209, s[30:31]
    v_addc_co_u32 v209, s[36:37], 0, v209, s[32:33]
    v_addc_co_u32 v209, s[36:37], 0, v209, s[34:35]
    s_cbranch_vccz L_GMDG
    ds_read_b32 v215, v221 offset:64
    ds_read_b128 v[216:219], v222 offset:64
    s_add_u32 s62, s62, 1
    s_cmp_lt_u32 s62, 2097152
    s_cbranch_scc1 L_GMWG
    s_waitcnt lgkmcnt(0)
L_GMDG:
    v_mov_b32 v216, v209
    s_nop 1
    v_permlane32_swap_b32 v209, v216
    v_add_u32 v209, v209, v216
    v_mov_b32 v216, v209
    s_nop 1
    v_permlane16_swap_b32 v209, v216
    v_add_u32 v209, v209, v216
    v_cmp_eq_u32 vcc, 7, v209
    s_ff1_i32_b64 s41, vcc
    s_and_b32 s41, s41, 63
    v_readlane_b32 s41, v215, s41
    s_nop 1
    v_cmp_le_u32 s[28:29], s41, v212
    v_cmp_le_u32 s[30:31], s41, v213
    v_cmp_le_u32 vcc, s41, v214
    v_mbcnt_lo_u32_b32 v216, s28, 0
    v_mbcnt_lo_u32_b32 v217, s30, 0
    v_mbcnt_hi_u32_b32 v216, s29, v216
    v_mbcnt_hi_u32_b32 v217, s31, v217
    v_min_u32 v216, 7, v216
    v_min_u32 v217, 7, v217
    v_lshl_add_u32 v216, v216, 2, s26
    v_lshlrev_b32 v217, 2, v217
    v_sub_u32 v217, s27, v217
    v_cndmask_b32 v216, v225, v216, s[28:29]
    v_cndmask_b32 v217, v225, v217, s[30:31]
    ds_write_b32 v216, v212 offset:128
    ds_write_b32 v217, v213 offset:128
    s_cbranch_vccnz L_TKFG
    s_bcnt1_i32_b64 s28, s[28:29]
    s_bcnt1_i32_b64 s30, s[30:31]
    s_add_u32 s28, s28, s30
    s_cmp_le_u32 s28, 8
    s_cbranch_scc1 L_TKPG
L_TKFG:
    s_mov_b32 s41, 0
L_TKFLG:
    v_max3_u32 v210, v200, v201, v202
    v_max3_u32 v210, v210, v203, v204
    v_max3_u32 v210, v210, v205, v206
    v_max_u32 v210, v210, v207
    s_nop 1
    v_max_u32_dpp v210, v210, v210 quad_perm:[1,0,3,2] row_mask:0xf bank_mask:0xf
    s_nop 1
    v_max_u32_dpp v210, v210, v210 quad_perm:[2,3,0,1] row_mask:0xf bank_mask:0xf
    s_nop 1
    v_max_u32_dpp v210, v210, v210 row_half_mirror row_mask:0xf bank_mask:0xf
    s_nop 1
    v_max_u32_dpp v210, v210, v210 row_mirror row_mask:0xf bank_mask:0xf
    s_nop 1
    v_max_u32_dpp v210, v210, v210 row_bcast:15 row_mask:0xa bank_mask:0xf
    s_nop 1
    v_max_u32_dpp v210, v210, v210 row_bcast:31 row_mask:0xc bank_mask:0xf
    s_nop 0
    v_readlane_b32 s28, v210, 63
    s_mov_b32 m0, s41
    s_nop 0
    v_writelane_b32 v209, s28, m0
    v_cmp_ne_u32 vcc, s28, v200
    s_nop 1
    v_cndmask_b32 v200, 0, v200, vcc
    v_cmp_ne_u32 vcc, s28, v201
    s_nop 1
    v_cndmask_b32 v201, 0, v201, vcc
    v_cmp_ne_u32 vcc, s28, v202
    s_nop 1
    v_cndmask_b32 v202, 0, v202, vcc
    v_cmp_ne_u32 vcc, s28, v203
    s_nop 1
    v_cndmask_b32 v203, 0, v203, vcc
    v_cmp_ne_u32 vcc, s28, v204
    s_nop 1
    v_cndmask_b32 v204, 0, v204, vcc
    v_cmp_ne_u32 vcc, s28, v205
    s_nop 1
    v_cndmask_b32 v205, 0, v205, vcc
    v_cmp_ne_u32 vcc, s28, v206
    s_nop 1
    v_cndmask_b32 v206, 0, v206, vcc
    v_cmp_ne_u32 vcc, s28, v207
    s_nop 1
    v_cndmask_b32 v207, 0, v207, vcc
    s_add_u32 s41, s41, 1
    s_cmp_lt_u32 s41, 8
    s_cbranch_scc1 L_TKFLG
    s_mov_b64 exec, 0xff
    ds_write_b32 v223, v209 offset:128
    s_mov_b64 exec, -1
L_TKPG:
    s_mov_b64 exec, 1
    ds_add_u32 v3, v2 offset:16
    s_mov_b64 exec, -1
    s_mov_b32 s62, 0
L_TKWG:
    ds_read_b32 v208, v3 offset:16
    ds_read_b32 v215, v223 offset:128
    ds_read_b128 v[216:219], v224 offset:128
    s_add_u32 s62, s62, 1
    s_waitcnt lgkmcnt(0)
    v_cmp_le_u32 vcc, 4, v208
    v_cmp_gt_u32 s[28:29], v216, v215
    v_cmp_gt_u32 s[30:31], v217, v215
    v_cmp_gt_u32 s[32:33], v218, v215
    v_cmp_gt_u32 s[34:35], v219, v215
    v_addc_co_u32 v209, s[36:37], 0, v3, s[28:29]
    v_addc_co_u32 v209, s[36:37], 0, v209, s[30:31]
    v_addc_co_u32 v209, s[36:37], 0, v209, s[32:33]
    v_addc_co_u32 v209, s[36:37], 0, v209, s[34:35]
    s_cbranch_vccnz L_TKDG
    s_cmp_lt_u32 s62, 2097152
    s_cbranch_scc1 L_TKWG
L_TKDG:
    s_nop 0
    v_add_u32_dpp v209, v209, v209 row_ror:8 row_mask:0xf bank_mask:0xf
    v_mov_b32 v216, v209
    s_nop 1
    v_permlane32_swap_b32 v209, v216
    v_add_u32 v209, v209, v216
    v_mov_b32 v216, v209
    s_nop 1
    v_permlane16_swap_b32 v209, v216
    v_add_u32 v209, v209, v216
    v_cmp_gt_u32 vcc, 8, v209
    v_lshlrev_b32 v209, 2, v209
    s_nop 0
    v_cndmask_b32 v209, v226, v209, vcc
    ds_write_b32 v209, v215 offset:256
    s_mov_b32 s62, 0
L_AGW:
    ds_read_b32 v24, v5 offset:256
    ds_read_b32 v26, v5 offset:260
    s_add_u32 s62, s62, 1
    s_waitcnt lgkmcnt(0)
    v_min_u32 v10, v24, v26
    v_cmp_eq_u32 vcc, 0, v10
    s_cbranch_vccz L_AGD
    s_cmp_lt_u32 s62, 2097152
    s_cbranch_scc1 L_AGW
L_AGD:
    buffer_store_dwordx4 v[24:27], v6, s[8:11], s19 offen sc1
    s_cmp_lg_u32 s19, 524288
    s_cbranch_scc1 L_MEND
    s_mov_b64 exec, 1
    buffer_store_dword v253, off, s[8:11], 0 sc1
    s_branch L_MEND
L_S:
    s_mul_i32 s43, s3, 8768
    s_add_u32 s43, s43, 1024
    s_mul_i32 s44, s3, 4672
    s_add_u32 s44, s44, 103936
    s_mul_i32 s45, s3, 4096
    s_add_u32 s45, s45, 71168
    s_add_u32 s46, s43, 5184
    s_mov_b32 m0, s43
    s_mov_b32 s48, 0xffff0000
    s_and_b32 s41, s3, 3
    s_lshl_b32 s49, s39, 2
    s_add_u32 s49, s49, s41
    s_lshl_b32 s49, s49, 12
    s_add_u32 s49, s49, 3407872
    v_mov_b32 v16, 0
    v_mov_b32 v17, 0
    v_mov_b32 v18, 0
    v_mov_b32 v19, 0
    v_lshl_add_u32 v14, v1, 3, s44
    v_lshl_add_u32 v15, v1, 4, s45
    s_mov_b32 exec_hi, 0x0fffffff
    ds_write_b64 v14, v[16:17]
    s_mov_b64 exec, -1
    ds_write_b128 v15, v[16:19] offset:0
    ds_write_b128 v15, v[16:19] offset:1024
    ds_write_b128 v15, v[16:19] offset:2048
    ds_write_b128 v15, v[16:19] offset:3072
    v_mov_b32 v29, 0x3f803f80
    ds_write_addtid_b32 v29
    ds_write_addtid_b32 v16 offset:256
    v_and_b32 v17, 15, v1
    v_lshrrev_b32 v18, 4, v1
    v_mul_u32_u24 v19, 544, v17
    v_lshl_add_u32 v19, v18, 4, v19
    v_add_u32 v19, s43, v19
    v_and_b32 v20, 31, v1
    v_lshrrev_b32 v21, 4, v20
    v_lshl_add_u32 v20, v21, 8, v20
    v_lshrrev_b32 v21, 5, v1
    v_mul_u32_u24 v21, 1220, v21
    v_lshl_add_u32 v20, v20, 2, v21
    v_add_u32 v20, s43, v20
    v_lshlrev_b32 v4, 5, v17
    v_lshl_add_u32 v4, v18, 4, v4
    v_add_u32 v4, s44, v4
    v_and_b32 v6, 3, v17
    v_mul_u32_u24 v6, 320, v6
    v_lshrrev_b32 v21, 2, v17
    v_sub_u32 v21, v18, v21
    v_lshl_add_u32 v6, v21, 4, v6
    v_add3_u32 v170, v6, 48, s45
    v_lshlrev_b32 v7, 5, v17
    v_lshl_add_u32 v7, v18, 3, v7
    s_add_u32 s41, s44, 480
    v_add_u32 v5, s41, v7
    v_lshlrev_b32 v6, 1, v7
    v_add_u32 v6, 141312, v6
    v_add_u32 v7, s43, v7
    v_and_b32 v21, 1, v17
    v_mul_u32_u24 v21, 1220, v21
    v_lshrrev_b32 v22, 1, v17
    v_lshl_add_u32 v21, v22, 2, v21
    v_lshlrev_b32 v22, 4, v18
    v_sub_u32 v21, v22, v21
    s_add_u32 s41, s43, 1248
    v_add_u32 v162, s41, v21
    v_mov_b32 v21, 0x3000
    v_lshlrev_b32 v21, v17, v21
    v_lshlrev_b32 v22, 3, v18
    v_lshrrev_b32 v21, v22, v21
    s_mov_b32 s41, 0x10001
    v_bfe_u32 v22, v21, 0, 2
    v_lshl_or_b32 v22, v22, 15, v22
    v_and_b32 v22, s41, v22
    v_mul_u32_u24 v164, 0xffff, v22
    v_bfe_u32 v22, v21, 2, 2
    v_lshl_or_b32 v22, v22, 15, v22
    v_and_b32 v22, s41, v22
    v_mul_u32_u24 v165, 0xffff, v22
    v_bfe_u32 v22, v21, 4, 2
    v_lshl_or_b32 v22, v22, 15, v22
    v_and_b32 v22, s41, v22
    v_mul_u32_u24 v166, 0xffff, v22
    v_bfe_u32 v22, v21, 6, 2
    v_lshl_or_b32 v22, v22, 15, v22
    v_and_b32 v22, s41, v22
    v_mul_u32_u24 v167, 0xffff, v22
    s_cmp_ge_u32 s3, 4
    s_cbranch_scc1 L_B
    v_lshlrev_b32 v25, 5, v17
    v_and_b32 v26, 1, v18
    v_lshl_add_u32 v25, v26, 4, v25
    v_lshrrev_b32 v27, 1, v18
    v_lshl_add_u32 v25, v27, 9, v25
    v_add_u32 v25, s46, v25
    v_lshlrev_b32 v28, 4, v17
    v_lshl_add_u32 v28, v26, 8, v28
    v_add_u32 v28, 1024, v28
    v_lshlrev_b32 v29, 3, v17
    v_lshl_add_u32 v29, v26, 8, v29
    v_add_u32 v29, 1536, v29
    v_cmp_eq_u32 vcc, 1, v27
    v_mov_b32 v30, 8
    v_mov_b32 v31, 128
    v_cndmask_b32 v26, v28, v29, vcc
    v_cndmask_b32 v27, v30, v31, vcc
    v_add_u32 v26, s46, v26
    v_add_u32 v27, v26, v27
    v_lshlrev_b32 v28, 2, v17
    v_lshl_add_u32 v28, v18, 8, v28
    v_add_u32 v28, s46, v28
    v_add_u32 v28, 2048, v28
    v_cmp_eq_u32 vcc, 0, v1
    s_waitcnt vmcnt(0)
    v_mul_f32 v12, 1069066811, v12
    v_lshlrev_b32 v32, 16, v8
    v_and_b32 v33, s48, v8
    v_exp_f32 v12, v12
    v_mul_f32 v32, 1069066811, v32
    v_mul_f32 v33, 1069066811, v33
    v_exp_f32 v32, v32
    v_exp_f32 v33, v33
    v_cvt_pk_bf16_f32 v12, v12, v12
    v_lshlrev_b32 v34, 16, v9
    v_and_b32 v35, s48, v9
    v_cvt_pk_bf16_f32 v8, v32, v33
    v_and_b32 v12, s48, v12
    v_lshlrev_b32 v32, 16, v8
    v_and_b32 v33, s48, v8
    v_mul_f32 v34, v34, v12
    v_mul_f32 v35, v35, v12
    v_mul_f32 v32, v32, v12
    v_mul_f32 v33, v33, v12
    v_mul_f32 v34, 0.15915494, v34
    v_mul_f32 v35, 0.15915494, v35
    v_mul_f32 v32, 0xbfb8aa3b, v32
    v_mul_f32 v33, 0xbfb8aa3b, v33
    v_mul_f32 v12, -2.0, v12
    v_cndmask_b32 v13, 0, v13, vcc
    v_lshlrev_b32 v56, 16, v10
    v_and_b32 v57, s48, v10
    v_lshlrev_b32 v58, 16, v11
    v_and_b32 v59, s48, v11
    v_mul_f32 v56, v56, v12
    v_mul_f32 v57, v57, v12
    v_mul_f32 v58, v58, v12
    v_mul_f32 v59, v59, v12
    v_mul_f32 v64, 0x41000000, v32
    v_mul_f32 v66, 0x41000000, v34
    v_mul_f32 v65, 0x41000000, v33
    v_mul_f32 v67, 0x41000000, v35
    v_rndne_f32 v48, v66
    v_exp_f32 v64, v64
    v_rndne_f32 v49, v67
    v_exp_f32 v65, v65
    v_sub_f32 v66, v48, v66
    v_sub_f32 v67, v49, v67
    v_cos_f32 v48, v66
    v_sin_f32 v50, v66
    v_cos_f32 v49, v67
    v_sin_f32 v51, v67
    v_pk_mul_f32 v[48:49], v[48:49], v[64:65]
    v_pk_mul_f32 v[50:51], v[50:51], v[64:65]
    .p2align 3
    v_cvt_pk_bf16_f32 v145, v50, v51
    v_cvt_pk_bf16_f32 v144, v48, v49
    v_pk_mul_f32 v[64:65], v[50:51], v[50:51]
    v_pk_mul_f32 v[66:67], v[50:51], v[48:49]
    v_pk_fma_f32 v[62:63], v[48:49], v[50:51], v[66:67]
    v_pk_fma_f32 v[60:61], v[48:49], v[48:49], v[64:65] neg_lo:[0,0,1] neg_hi:[0,0,1]
    v_cvt_pk_bf16_f32 v147, v62, v63
    v_cvt_pk_bf16_f32 v146, v60, v61
    v_pk_mul_f32 v[64:65], v[62:63], v[50:51]
    v_pk_mul_f32 v[66:67], v[62:63], v[48:49]
    v_pk_fma_f32 v[62:63], v[60:61], v[50:51], v[66:67]
    v_pk_fma_f32 v[60:61], v[60:61], v[48:49], v[64:65] neg_lo:[0,0,1] neg_hi:[0,0,1]
    v_cvt_pk_bf16_f32 v149, v62, v63
    v_cvt_pk_bf16_f32 v148, v60, v61
    v_pk_mul_f32 v[64:65], v[62:63], v[50:51]
    v_pk_mul_f32 v[66:67], v[62:63], v[48:49]
    v_pk_fma_f32 v[62:63], v[60:61], v[50:51], v[66:67]
    v_pk_fma_f32 v[60:61], v[60:61], v[48:49], v[64:65] neg_lo:[0,0,1] neg_hi:[0,0,1]
    v_cvt_pk_bf16_f32 v151, v62, v63
    v_cvt_pk_bf16_f32 v150, v60, v61
    v_pk_mul_f32 v[64:65], v[62:63], v[50:51]
    v_pk_mul_f32 v[66:67], v[62:63], v[48:49]
    v_pk_fma_f32 v[62:63], v[60:61], v[50:51], v[66:67]
    v_pk_fma_f32 v[60:61], v[60:61], v[48:49], v[64:65] neg_lo:[0,0,1] neg_hi:[0,0,1]
    v_cvt_pk_bf16_f32 v153, v62, v63
    v_cvt_pk_bf16_f32 v152, v60, v61
    v_pk_mul_f32 v[64:65], v[62:63], v[50:51]
    v_pk_mul_f32 v[66:67], v[62:63], v[48:49]
    v_pk_fma_f32 v[62:63], v[60:61], v[50:51], v[66:67]
    v_pk_fma_f32 v[60:61], v[60:61], v[48:49], v[64:65] neg_lo:[0,0,1] neg_hi:[0,0,1]
    v_cvt_pk_bf16_f32 v155, v62, v63
    v_cvt_pk_bf16_f32 v154, v60, v61
    v_pk_mul_f32 v[64:65], v[62:63], v[50:51]
    v_pk_mul_f32 v[66:67], v[62:63], v[48:49]
    v_pk_fma_f32 v[62:63], v[60:61], v[50:51], v[66:67]
    v_pk_fma_f32 v[60:61], v[60:61], v[48:49], v[64:65] neg_lo:[0,0,1] neg_hi:[0,0,1]
    v_cvt_pk_bf16_f32 v157, v62, v63
    v_cvt_pk_bf16_f32 v156, v60, v61
    ds_write_addtid_b32 v144 offset:544
    ds_write_addtid_b32 v145 offset:800
    ds_write_addtid_b32 v146 offset:1088
    ds_write_addtid_b32 v147 offset:1344
    ds_write_addtid_b32 v148 offset:1632
    ds_write_addtid_b32 v149 offset:1888
    ds_write_addtid_b32 v150 offset:2176
    ds_write_addtid_b32 v151 offset:2432
    ds_write_addtid_b32 v152 offset:2720
    ds_write_addtid_b32 v153 offset:2976
    ds_write_addtid_b32 v154 offset:3264
    ds_write_addtid_b32 v155 offset:3520
    ds_write_addtid_b32 v156 offset:3808
    ds_write_addtid_b32 v157 offset:4064
    v_pk_mul_f32 v[64:65], v[62:63], v[50:51]
    v_pk_mul_f32 v[66:67], v[62:63], v[48:49]
    v_pk_fma_f32 v[62:63], v[60:61], v[50:51], v[66:67]
    v_pk_fma_f32 v[60:61], v[60:61], v[48:49], v[64:65] neg_lo:[0,0,1] neg_hi:[0,0,1]
    v_cvt_pk_bf16_f32 v145, v62, v63
    v_cvt_pk_bf16_f32 v144, v60, v61
    v_pk_mul_f32 v[64:65], v[62:63], v[50:51]
    v_pk_mul_f32 v[66:67], v[62:63], v[48:49]
    v_pk_fma_f32 v[62:63], v[60:61], v[50:51], v[66:67]
    v_pk_fma_f32 v[60:61], v[60:61], v[48:49], v[64:65] neg_lo:[0,0,1] neg_hi:[0,0,1]
    v_cvt_pk_bf16_f32 v147, v62, v63
    v_cvt_pk_bf16_f32 v146, v60, v61
    v_pk_mul_f32 v[64:65], v[62:63], v[50:51]
    v_pk_mul_f32 v[66:67], v[62:63], v[48:49]
    v_pk_fma_f32 v[62:63], v[60:61], v[50:51], v[66:67]
    v_pk_fma_f32 v[60:61], v[60:61], v[48:49], v[64:65] neg_lo:[0,0,1] neg_hi:[0,0,1]
    v_cvt_pk_bf16_f32 v149, v62, v63
    v_cvt_pk_bf16_f32 v148, v60, v61
    v_pk_mul_f32 v[64:65], v[62:63], v[50:51]
    v_pk_mul_f32 v[66:67], v[62:63], v[48:49]
    v_pk_fma_f32 v[62:63], v[60:61], v[50:51], v[66:67]
    v_pk_fma_f32 v[60:61], v[60:61], v[48:49], v[64:65] neg_lo:[0,0,1] neg_hi:[0,0,1]
    v_cvt_pk_bf16_f32 v151, v62, v63
    v_cvt_pk_bf16_f32 v150, v60, v61
    v_pk_mul_f32 v[64:65], v[62:63], v[50:51]
    v_pk_mul_f32 v[66:67], v[62:63], v[48:49]
    v_pk_fma_f32 v[62:63], v[60:61], v[50:51], v[66:67]
    v_pk_fma_f32 v[60:61], v[60:61], v[48:49], v[64:65] neg_lo:[0,0,1] neg_hi:[0,0,1]
    v_cvt_pk_bf16_f32 v153, v62, v63
    v_cvt_pk_bf16_f32 v152, v60, v61
    v_pk_mul_f32 v[64:65], v[62:63], v[50:51]
    v_pk_mul_f32 v[66:67], v[62:63], v[48:49]
    v_pk_fma_f32 v[62:63], v[60:61], v[50:51], v[66:67]
    v_pk_fma_f32 v[60:61], v[60:61], v[48:49], v[64:65] neg_lo:[0,0,1] neg_hi:[0,0,1]
    v_cvt_pk_bf16_f32 v155, v62, v63
    v_cvt_pk_bf16_f32 v154, v60, v61
    v_pk_mul_f32 v[64:65], v[62:63], v[50:51]
    v_pk_mul_f32 v[66:67], v[62:63], v[48:49]
    v_pk_fma_f32 v[62:63], v[60:61], v[50:51], v[66:67]
    v_pk_fma_f32 v[60:61], v[60:61], v[48:49], v[64:65] neg_lo:[0,0,1] neg_hi:[0,0,1]
    v_cvt_pk_bf16_f32 v157, v62, v63
    v_cvt_pk_bf16_f32 v156, v60, v61
    v_pk_mul_f32 v[64:65], v[62:63], v[50:51]
    v_pk_mul_f32 v[66:67], v[62:63], v[48:49]
    v_pk_fma_f32 v[62:63], v[60:61], v[50:51], v[66:67]
    v_pk_fma_f32 v[60:61], v[60:61], v[48:49], v[64:65] neg_lo:[0,0,1] neg_hi:[0,0,1]
    v_cvt_pk_bf16_f32 v159, v62, v63
    v_cvt_pk_bf16_f32 v158, v60, v61
    ds_write_addtid_b32 v144 offset:4352
    ds_write_addtid_b32 v145 offset:4608
    ds_write_addtid_b32 v146 offset:4896
    ds_write_addtid_b32 v147 offset:5152
    ds_write_addtid_b32 v148 offset:5440
    ds_write_addtid_b32 v149 offset:5696
    ds_write_addtid_b32 v150 offset:5984
    ds_write_addtid_b32 v151 offset:6240
    ds_write_addtid_b32 v152 offset:6528
    ds_write_addtid_b32 v153 offset:6784
    ds_write_addtid_b32 v154 offset:7072
    ds_write_addtid_b32 v155 offset:7328
    ds_write_addtid_b32 v156 offset:7616
    ds_write_addtid_b32 v157 offset:7872
    ds_write_addtid_b32 v158 offset:8160
    ds_write_addtid_b32 v159 offset:8416
    ds_read_b128 v[68:71], v19 offset:0
    ds_read_b128 v[72:75], v19 offset:64
    ds_read_b128 v[76:79], v19 offset:128
    ds_read_b128 v[80:83], v19 offset:192
    ds_read_b128 v[84:87], v19 offset:256
    ds_read_b128 v[88:91], v19 offset:320
    ds_read_b128 v[92:95], v19 offset:384
    ds_read_b128 v[96:99], v19 offset:448
    v_rndne_f32 v36, v34
    v_exp_f32 v64, v32
    v_rndne_f32 v37, v35
    v_exp_f32 v65, v33
    v_sub_f32 v66, v34, v36
    v_sub_f32 v67, v35, v37
    v_cos_f32 v36, v66
    v_sin_f32 v38, v66
    v_cos_f32 v37, v67
    v_sin_f32 v39, v67
    v_pk_mul_f32 v[36:37], v[36:37], v[64:65]
    v_pk_mul_f32 v[38:39], v[38:39], v[64:65]
    v_mul_f32 v64, 0x43000000, v32
    v_mul_f32 v66, 0x43000000, v34
    v_mul_f32 v65, 0x43000000, v33
    v_mul_f32 v67, 0x43000000, v35
    v_rndne_f32 v52, v66
    v_exp_f32 v64, v64
    v_rndne_f32 v53, v67
    v_exp_f32 v65, v65
    v_sub_f32 v66, v66, v52
    v_sub_f32 v67, v67, v53
    v_cos_f32 v52, v66
    v_sin_f32 v54, v66
    v_cos_f32 v53, v67
    v_sin_f32 v55, v67
    v_pk_mul_f32 v[52:53], v[52:53], v[64:65]
    v_pk_mul_f32 v[54:55], v[54:55], v[64:65]
    .p2align 3
    v_pk_mul_f32 v[64:65], v[38:39], v[38:39]
    v_pk_mul_f32 v[66:67], v[38:39], v[36:37]
    v_pk_fma_f32 v[42:43], v[36:37], v[38:39], v[66:67]
    v_pk_fma_f32 v[40:41], v[36:37], v[36:37], v[64:65] neg_lo:[0,0,1] neg_hi:[0,0,1]
    v_pk_mul_f32 v[64:65], v[42:43], v[42:43]
    v_pk_mul_f32 v[66:67], v[42:43], v[40:41]
    v_pk_fma_f32 v[46:47], v[40:41], v[42:43], v[66:67]
    v_pk_fma_f32 v[44:45], v[40:41], v[40:41], v[64:65] neg_lo:[0,0,1] neg_hi:[0,0,1]
    v_cvt_pk_bf16_f32 v145, v58, v59
    v_cvt_pk_bf16_f32 v144, v56, v57
    v_pk_mul_f32 v[64:65], v[58:59], v[38:39]
    v_pk_mul_f32 v[66:67], v[58:59], v[36:37]
    v_pk_fma_f32 v[62:63], v[56:57], v[38:39], v[66:67]
    v_pk_fma_f32 v[60:61], v[56:57], v[36:37], v[64:65] neg_lo:[0,0,1] neg_hi:[0,0,1]
    v_cvt_pk_bf16_f32 v147, v62, v63
    v_cvt_pk_bf16_f32 v146, v60, v61
    v_pk_mul_f32 v[64:65], v[62:63], v[38:39]
    v_pk_mul_f32 v[66:67], v[62:63], v[36:37]
    v_pk_fma_f32 v[62:63], v[60:61], v[38:39], v[66:67]
    v_pk_fma_f32 v[60:61], v[60:61], v[36:37], v[64:65] neg_lo:[0,0,1] neg_hi:[0,0,1]
    v_cvt_pk_bf16_f32 v149, v62, v63
    v_cvt_pk_bf16_f32 v148, v60, v61
    v_pk_mul_f32 v[64:65], v[62:63], v[38:39]
    v_pk_mul_f32 v[66:67], v[62:63], v[36:37]
    v_pk_fma_f32 v[62:63], v[60:61], v[38:39], v[66:67]
    v_pk_fma_f32 v[60:61], v[60:61], v[36:37], v[64:65] neg_lo:[0,0,1] neg_hi:[0,0,1]
    v_cvt_pk_bf16_f32 v151, v62, v63
    v_cvt_pk_bf16_f32 v150, v60, v61
    v_pk_mul_f32 v[64:65], v[62:63], v[38:39]
    v_pk_mul_f32 v[66:67], v[62:63], v[36:37]
    v_pk_fma_f32 v[62:63], v[60:61], v[38:39], v[66:67]
    v_pk_fma_f32 v[60:61], v[60:61], v[36:37], v[64:65] neg_lo:[0,0,1] neg_hi:[0,0,1]
    v_cvt_pk_bf16_f32 v153, v62, v63
    v_cvt_pk_bf16_f32 v152, v60, v61
    v_pk_mul_f32 v[64:65], v[62:63], v[38:39]
    v_pk_mul_f32 v[66:67], v[62:63], v[36:37]
    v_pk_fma_f32 v[62:63], v[60:61], v[38:39], v[66:67]
    v_pk_fma_f32 v[60:61], v[60:61], v[36:37], v[64:65] neg_lo:[0,0,1] neg_hi:[0,0,1]
    v_cvt_pk_bf16_f32 v155, v62, v63
    v_cvt_pk_bf16_f32 v154, v60, v61
    v_pk_mul_f32 v[64:65], v[62:63], v[38:39]
    v_pk_mul_f32 v[66:67], v[62:63], v[36:37]
    v_pk_fma_f32 v[62:63], v[60:61], v[38:39], v[66:67]
    v_pk_fma_f32 v[60:61], v[60:61], v[36:37], v[64:65] neg_lo:[0,0,1] neg_hi:[0,0,1]
    v_cvt_pk_bf16_f32 v157, v62, v63
    v_cvt_pk_bf16_f32 v156, v60, v61
    v_pk_mul_f32 v[64:65], v[62:63], v[38:39]
    v_pk_mul_f32 v[66:67], v[62:63], v[36:37]
    v_pk_fma_f32 v[62:63], v[60:61], v[38:39], v[66:67]
    v_pk_fma_f32 v[60:61], v[60:61], v[36:37], v[64:65] neg_lo:[0,0,1] neg_hi:[0,0,1]
    v_cvt_pk_bf16_f32 v159, v62, v63
    v_cvt_pk_bf16_f32 v158, v60, v61
    ds_write_addtid_b32 v144 offset:0
    ds_write_addtid_b32 v145 offset:256
    ds_write_addtid_b32 v146 offset:544
    ds_write_addtid_b32 v147 offset:800
    ds_write_addtid_b32 v148 offset:1088
    ds_write_addtid_b32 v149 offset:1344
    ds_write_addtid_b32 v150 offset:1632
    ds_write_addtid_b32 v151 offset:1888
    ds_write_addtid_b32 v152 offset:2176
    ds_write_addtid_b32 v153 offset:2432
    ds_write_addtid_b32 v154 offset:2720
    ds_write_addtid_b32 v155 offset:2976
    ds_write_addtid_b32 v156 offset:3264
    ds_write_addtid_b32 v157 offset:3520
    ds_write_addtid_b32 v158 offset:3808
    ds_write_addtid_b32 v159 offset:4064
    v_pk_mul_f32 v[64:65], v[58:59], v[54:55]
    v_pk_mul_f32 v[66:67], v[58:59], v[52:53]
    v_pk_fma_f32 v[58:59], v[56:57], v[54:55], v[66:67]
    v_pk_fma_f32 v[56:57], v[56:57], v[52:53], v[64:65] neg_lo:[0,0,1] neg_hi:[0,0,1]
    v_cvt_pk_bf16_f32 v145, v58, v59
    v_cvt_pk_bf16_f32 v144, v56, v57
    v_pk_mul_f32 v[64:65], v[58:59], v[38:39]
    v_pk_mul_f32 v[66:67], v[58:59], v[36:37]
    v_pk_fma_f32 v[62:63], v[56:57], v[38:39], v[66:67]
    v_pk_fma_f32 v[60:61], v[56:57], v[36:37], v[64:65] neg_lo:[0,0,1] neg_hi:[0,0,1]
    v_cvt_pk_bf16_f32 v147, v62, v63
    v_cvt_pk_bf16_f32 v146, v60, v61
    v_pk_mul_f32 v[64:65], v[62:63], v[38:39]
    v_pk_mul_f32 v[66:67], v[62:63], v[36:37]
    v_pk_fma_f32 v[62:63], v[60:61], v[38:39], v[66:67]
    v_pk_fma_f32 v[60:61], v[60:61], v[36:37], v[64:65] neg_lo:[0,0,1] neg_hi:[0,0,1]
    v_cvt_pk_bf16_f32 v149, v62, v63
    v_cvt_pk_bf16_f32 v148, v60, v61
    v_pk_mul_f32 v[64:65], v[62:63], v[38:39]
    v_pk_mul_f32 v[66:67], v[62:63], v[36:37]
    v_pk_fma_f32 v[62:63], v[60:61], v[38:39], v[66:67]
    v_pk_fma_f32 v[60:61], v[60:61], v[36:37], v[64:65] neg_lo:[0,0,1] neg_hi:[0,0,1]
    v_cvt_pk_bf16_f32 v151, v62, v63
    v_cvt_pk_bf16_f32 v150, v60, v61
    v_pk_mul_f32 v[64:65], v[62:63], v[38:39]
    v_pk_mul_f32 v[66:67], v[62:63], v[36:37]
    v_pk_fma_f32 v[62:63], v[60:61], v[38:39], v[66:67]
    v_pk_fma_f32 v[60:61], v[60:61], v[36:37], v[64:65] neg_lo:[0,0,1] neg_hi:[0,0,1]
    v_cvt_pk_bf16_f32 v153, v62, v63
    v_cvt_pk_bf16_f32 v152, v60, v61
    v_pk_mul_f32 v[64:65], v[62:63], v[38:39]
    v_pk_mul_f32 v[66:67], v[62:63], v[36:37]
    v_pk_fma_f32 v[62:63], v[60:61], v[38:39], v[66:67]
    v_pk_fma_f32 v[60:61], v[60:61], v[36:37], v[64:65] neg_lo:[0,0,1] neg_hi:[0,0,1]
    v_cvt_pk_bf16_f32 v155, v62, v63
    v_cvt_pk_bf16_f32 v154, v60, v61
    v_pk_mul_f32 v[64:65], v[62:63], v[38:39]
    v_pk_mul_f32 v[66:67], v[62:63], v[36:37]
    v_pk_fma_f32 v[62:63], v[60:61], v[38:39], v[66:67]
    v_pk_fma_f32 v[60:61], v[60:61], v[36:37], v[64:65] neg_lo:[0,0,1] neg_hi:[0,0,1]
    v_cvt_pk_bf16_f32 v157, v62, v63
    v_cvt_pk_bf16_f32 v156, v60, v61
    v_pk_mul_f32 v[64:65], v[62:63], v[38:39]
    v_pk_mul_f32 v[66:67], v[62:63], v[36:37]
    v_pk_fma_f32 v[62:63], v[60:61], v[38:39], v[66:67]
    v_pk_fma_f32 v[60:61], v[60:61], v[36:37], v[64:65] neg_lo:[0,0,1] neg_hi:[0,0,1]
    v_cvt_pk_bf16_f32 v159, v62, v63
    v_cvt_pk_bf16_f32 v158, v60, v61
    ds_write_addtid_b32 v144 offset:4352
    ds_write_addtid_b32 v145 offset:4608
    ds_write_addtid_b32 v146 offset:4896
    ds_write_addtid_b32 v147 offset:5152
    ds_write_addtid_b32 v148 offset:5440
    ds_write_addtid_b32 v149 offset:5696
    ds_write_addtid_b32 v150 offset:5984
    ds_write_addtid_b32 v151 offset:6240
    ds_write_addtid_b32 v152 offset:6528
    ds_write_addtid_b32 v153 offset:6784
    ds_write_addtid_b32 v154 offset:7072
    ds_write_addtid_b32 v155 offset:7328
    ds_write_addtid_b32 v156 offset:7616
    ds_write_addtid_b32 v157 offset:7872
    ds_write_addtid_b32 v158 offset:8160
    ds_write_addtid_b32 v159 offset:8416
    ds_read_b128 v[100:103], v19 offset:0
    ds_read_b128 v[104:107], v19 offset:64
    ds_read_b128 v[108:111], v19 offset:128
    ds_read_b128 v[112:115], v19 offset:192
    ds_read_b128 v[116:119], v19 offset:256
    ds_read_b128 v[120:123], v19 offset:320
    ds_read_b128 v[124:127], v19 offset:384
    ds_read_b128 v[128:131], v19 offset:448
    v_pk_mul_f32 v[64:65], v[58:59], v[54:55]
    v_pk_mul_f32 v[66:67], v[58:59], v[52:53]
    v_pk_fma_f32 v[58:59], v[56:57], v[54:55], v[66:67]
    v_pk_fma_f32 v[56:57], v[56:57], v[52:53], v[64:65] neg_lo:[0,0,1] neg_hi:[0,0,1]
    v_cvt_pk_bf16_f32 v145, v58, v59
    v_cvt_pk_bf16_f32 v144, v56, v57
    v_pk_mul_f32 v[64:65], v[58:59], v[42:43]
    v_pk_mul_f32 v[66:67], v[58:59], v[40:41]
    v_pk_fma_f32 v[62:63], v[56:57], v[42:43], v[66:67]
    v_pk_fma_f32 v[60:61], v[56:57], v[40:41], v[64:65] neg_lo:[0,0,1] neg_hi:[0,0,1]
    v_cvt_pk_bf16_f32 v147, v62, v63
    v_cvt_pk_bf16_f32 v146, v60, v61
    v_pk_mul_f32 v[64:65], v[62:63], v[42:43]
    v_pk_mul_f32 v[66:67], v[62:63], v[40:41]
    v_pk_fma_f32 v[62:63], v[60:61], v[42:43], v[66:67]
    v_pk_fma_f32 v[60:61], v[60:61], v[40:41], v[64:65] neg_lo:[0,0,1] neg_hi:[0,0,1]
    v_cvt_pk_bf16_f32 v149, v62, v63
    v_cvt_pk_bf16_f32 v148, v60, v61
    v_pk_mul_f32 v[64:65], v[62:63], v[42:43]
    v_pk_mul_f32 v[66:67], v[62:63], v[40:41]
    v_pk_fma_f32 v[62:63], v[60:61], v[42:43], v[66:67]
    v_pk_fma_f32 v[60:61], v[60:61], v[40:41], v[64:65] neg_lo:[0,0,1] neg_hi:[0,0,1]
    v_cvt_pk_bf16_f32 v151, v62, v63
    v_cvt_pk_bf16_f32 v150, v60, v61
    v_pk_mul_f32 v[64:65], v[58:59], v[54:55]
    v_pk_mul_f32 v[66:67], v[58:59], v[52:53]
    v_pk_fma_f32 v[58:59], v[56:57], v[54:55], v[66:67]
    v_pk_fma_f32 v[56:57], v[56:57], v[52:53], v[64:65] neg_lo:[0,0,1] neg_hi:[0,0,1]
    v_cvt_pk_bf16_f32 v153, v58, v59
    v_cvt_pk_bf16_f32 v152, v56, v57
    v_pk_mul_f32 v[64:65], v[58:59], v[42:43]
    v_pk_mul_f32 v[66:67], v[58:59], v[40:41]
    v_pk_fma_f32 v[62:63], v[56:57], v[42:43], v[66:67]
    v_pk_fma_f32 v[60:61], v[56:57], v[40:41], v[64:65] neg_lo:[0,0,1] neg_hi:[0,0,1]
    v_cvt_pk_bf16_f32 v155, v62, v63
    v_cvt_pk_bf16_f32 v154, v60, v61
    v_pk_mul_f32 v[64:65], v[62:63], v[42:43]
    v_pk_mul_f32 v[66:67], v[62:63], v[40:41]
    v_pk_fma_f32 v[62:63], v[60:61], v[42:43], v[66:67]
    v_pk_fma_f32 v[60:61], v[60:61], v[40:41], v[64:65] neg_lo:[0,0,1] neg_hi:[0,0,1]
    v_cvt_pk_bf16_f32 v157, v62, v63
    v_cvt_pk_bf16_f32 v156, v60, v61
    v_pk_mul_f32 v[64:65], v[62:63], v[42:43]
    v_pk_mul_f32 v[66:67], v[62:63], v[40:41]
    v_pk_fma_f32 v[62:63], v[60:61], v[42:43], v[66:67]
    v_pk_fma_f32 v[60:61], v[60:61], v[40:41], v[64:65] neg_lo:[0,0,1] neg_hi:[0,0,1]
    v_cvt_pk_bf16_f32 v159, v62, v63
    v_cvt_pk_bf16_f32 v158, v60, v61
    s_waitcnt lgkmcnt(0)
    .p2align 3
    v_mfma_f32_16x16x32_bf16 v[132:135], v[100:103], v[68:71], 0
    ds_write_addtid_b32 v144 offset:0
    ds_write_addtid_b32 v145 offset:256
    v_mfma_f32_16x16x32_bf16 v[132:135], v[104:107], v[72:75], v[132:135]
    ds_write_addtid_b32 v146 offset:544
    ds_write_addtid_b32 v147 offset:800
    v_mfma_f32_16x16x32_bf16 v[132:135], v[108:111], v[76:79], v[132:135]
    ds_write_addtid_b32 v148 offset:1088
    ds_write_addtid_b32 v149 offset:1344
    v_mfma_f32_16x16x32_bf16 v[132:135], v[112:115], v[80:83], v[132:135]
    ds_write_addtid_b32 v150 offset:1632
    ds_write_addtid_b32 v151 offset:1888
    v_mfma_f32_16x16x32_bf16 v[132:135], v[116:119], v[84:87], v[132:135]
    ds_write_addtid_b32 v152 offset:2176
    ds_write_addtid_b32 v153 offset:2432
    v_mfma_f32_16x16x32_bf16 v[132:135], v[120:123], v[88:91], v[132:135]
    ds_write_addtid_b32 v154 offset:2720
    ds_write_addtid_b32 v155 offset:2976
    v_mfma_f32_16x16x32_bf16 v[132:135], v[124:127], v[92:95], v[132:135]
    ds_write_addtid_b32 v156 offset:3264
    ds_write_addtid_b32 v157 offset:3520
    v_mfma_f32_16x16x32_bf16 v[132:135], v[128:131], v[96:99], v[132:135]
    ds_write_addtid_b32 v158 offset:3808
    ds_write_addtid_b32 v159 offset:4064
    v_pk_mul_f32 v[64:65], v[58:59], v[54:55]
    v_pk_mul_f32 v[66:67], v[58:59], v[52:53]
    v_pk_fma_f32 v[58:59], v[56:57], v[54:55], v[66:67]
    v_pk_fma_f32 v[56:57], v[56:57], v[52:53], v[64:65] neg_lo:[0,0,1] neg_hi:[0,0,1]
    v_cvt_pk_bf16_f32 v145, v58, v59
    v_cvt_pk_bf16_f32 v144, v56, v57
    v_pk_mul_f32 v[64:65], v[58:59], v[46:47]
    v_pk_mul_f32 v[66:67], v[58:59], v[44:45]
    v_pk_fma_f32 v[62:63], v[56:57], v[46:47], v[66:67]
    v_pk_fma_f32 v[60:61], v[56:57], v[44:45], v[64:65] neg_lo:[0,0,1] neg_hi:[0,0,1]
    v_cvt_pk_bf16_f32 v147, v62, v63
    v_cvt_pk_bf16_f32 v146, v60, v61
    v_pk_mul_f32 v[64:65], v[58:59], v[54:55]
    v_pk_mul_f32 v[66:67], v[58:59], v[52:53]
    v_pk_fma_f32 v[58:59], v[56:57], v[54:55], v[66:67]
    v_pk_fma_f32 v[56:57], v[56:57], v[52:53], v[64:65] neg_lo:[0,0,1] neg_hi:[0,0,1]
    v_cvt_pk_bf16_f32 v149, v58, v59
    v_cvt_pk_bf16_f32 v148, v56, v57
    v_pk_mul_f32 v[64:65], v[58:59], v[46:47]
    v_pk_mul_f32 v[66:67], v[58:59], v[44:45]
    v_pk_fma_f32 v[62:63], v[56:57], v[46:47], v[66:67]
    v_pk_fma_f32 v[60:61], v[56:57], v[44:45], v[64:65] neg_lo:[0,0,1] neg_hi:[0,0,1]
    v_cvt_pk_bf16_f32 v151, v62, v63
    v_cvt_pk_bf16_f32 v150, v60, v61
    v_pk_mul_f32 v[64:65], v[58:59], v[54:55]
    v_pk_mul_f32 v[66:67], v[58:59], v[52:53]
    v_pk_fma_f32 v[58:59], v[56:57], v[54:55], v[66:67]
    v_pk_fma_f32 v[56:57], v[56:57], v[52:53], v[64:65] neg_lo:[0,0,1] neg_hi:[0,0,1]
    v_cvt_pk_bf16_f32 v153, v58, v59
    v_cvt_pk_bf16_f32 v152, v56, v57
    v_pk_mul_f32 v[64:65], v[58:59], v[46:47]
    v_pk_mul_f32 v[66:67], v[58:59], v[44:45]
    v_pk_fma_f32 v[62:63], v[56:57], v[46:47], v[66:67]
    v_pk_fma_f32 v[60:61], v[56:57], v[44:45], v[64:65] neg_lo:[0,0,1] neg_hi:[0,0,1]
    v_cvt_pk_bf16_f32 v155, v62, v63
    v_cvt_pk_bf16_f32 v154, v60, v61
    v_pk_mul_f32 v[64:65], v[58:59], v[54:55]
    v_pk_mul_f32 v[66:67], v[58:59], v[52:53]
    v_pk_fma_f32 v[58:59], v[56:57], v[54:55], v[66:67]
    v_pk_fma_f32 v[56:57], v[56:57], v[52:53], v[64:65] neg_lo:[0,0,1] neg_hi:[0,0,1]
    v_cvt_pk_bf16_f32 v157, v58, v59
    v_cvt_pk_bf16_f32 v156, v56, v57
    v_pk_mul_f32 v[64:65], v[58:59], v[46:47]
    v_pk_mul_f32 v[66:67], v[58:59], v[44:45]
    v_pk_fma_f32 v[62:63], v[56:57], v[46:47], v[66:67]
    v_pk_fma_f32 v[60:61], v[56:57], v[44:45], v[64:65] neg_lo:[0,0,1] neg_hi:[0,0,1]
    v_cvt_pk_bf16_f32 v159, v62, v63
    v_cvt_pk_bf16_f32 v158, v60, v61
    ds_write_addtid_b32 v144 offset:4352
    ds_write_addtid_b32 v145 offset:4608
    ds_write_addtid_b32 v146 offset:4896
    ds_write_addtid_b32 v147 offset:5152
    ds_write_addtid_b32 v148 offset:5440
    ds_write_addtid_b32 v149 offset:5696
    ds_write_addtid_b32 v150 offset:5984
    ds_write_addtid_b32 v151 offset:6240
    ds_write_addtid_b32 v152 offset:6528
    ds_write_addtid_b32 v153 offset:6784
    ds_write_addtid_b32 v154 offset:7072
    ds_write_addtid_b32 v155 offset:7328
    ds_write_addtid_b32 v156 offset:7616
    ds_write_addtid_b32 v157 offset:7872
    ds_write_addtid_b32 v158 offset:8160
    ds_write_addtid_b32 v159 offset:8416
    ds_read_b128 v[100:103], v19 offset:0
    ds_read_b128 v[104:107], v19 offset:64
    ds_read_b128 v[108:111], v19 offset:128
    ds_read_b128 v[112:115], v19 offset:192
    ds_read_b128 v[116:119], v19 offset:256
    ds_read_b128 v[120:123], v19 offset:320
    ds_read_b128 v[124:127], v19 offset:384
    ds_read_b128 v[128:131], v19 offset:448
    s_cmp_eq_u32 s47, 0
    s_cbranch_scc1 L_NKT
    s_mov_b64 exec, 1
    ds_add_u32 v3, v2 offset:4
    s_mov_b64 exec, -1
L_NKT:
    .p2align 3
    v_pk_mul_f32 v[64:65], v[58:59], v[54:55]
    v_pk_mul_f32 v[66:67], v[58:59], v[52:53]
    v_pk_fma_f32 v[58:59], v[56:57], v[54:55], v[66:67]
    v_pk_fma_f32 v[56:57], v[56:57], v[52:53], v[64:65] neg_lo:[0,0,1] neg_hi:[0,0,1]
    v_cvt_pk_bf16_f32 v145, v58, v59
    v_cvt_pk_bf16_f32 v144, v56, v57
    v_pk_mul_f32 v[64:65], v[58:59], v[54:55]
    v_pk_mul_f32 v[66:67], v[58:59], v[52:53]
    v_pk_fma_f32 v[58:59], v[56:57], v[54:55], v[66:67]
    v_pk_fma_f32 v[56:57], v[56:57], v[52:53], v[64:65] neg_lo:[0,0,1] neg_hi:[0,0,1]
    v_cvt_pk_bf16_f32 v147, v58, v59
    v_cvt_pk_bf16_f32 v146, v56, v57
    v_pk_mul_f32 v[64:65], v[58:59], v[54:55]
    v_pk_mul_f32 v[66:67], v[58:59], v[52:53]
    v_pk_fma_f32 v[58:59], v[56:57], v[54:55], v[66:67]
    v_pk_fma_f32 v[56:57], v[56:57], v[52:53], v[64:65] neg_lo:[0,0,1] neg_hi:[0,0,1]
    v_cvt_pk_bf16_f32 v149, v58, v59
    v_cvt_pk_bf16_f32 v148, v56, v57
    v_pk_mul_f32 v[64:65], v[58:59], v[54:55]
    v_pk_mul_f32 v[66:67], v[58:59], v[52:53]
    v_pk_fma_f32 v[58:59], v[56:57], v[54:55], v[66:67]
    v_pk_fma_f32 v[56:57], v[56:57], v[52:53], v[64:65] neg_lo:[0,0,1] neg_hi:[0,0,1]
    v_cvt_pk_bf16_f32 v151, v58, v59
    v_cvt_pk_bf16_f32 v150, v56, v57
    v_pk_mul_f32 v[64:65], v[58:59], v[54:55]
    v_pk_mul_f32 v[66:67], v[58:59], v[52:53]
    v_pk_fma_f32 v[58:59], v[56:57], v[54:55], v[66:67]
    v_pk_fma_f32 v[56:57], v[56:57], v[52:53], v[64:65] neg_lo:[0,0,1] neg_hi:[0,0,1]
    v_cvt_pk_bf16_f32 v153, v58, v59
    v_cvt_pk_bf16_f32 v152, v56, v57
    v_pk_mul_f32 v[64:65], v[58:59], v[54:55]
    v_pk_mul_f32 v[66:67], v[58:59], v[52:53]
    v_pk_fma_f32 v[58:59], v[56:57], v[54:55], v[66:67]
    v_pk_fma_f32 v[56:57], v[56:57], v[52:53], v[64:65] neg_lo:[0,0,1] neg_hi:[0,0,1]
    v_cvt_pk_bf16_f32 v155, v58, v59
    v_cvt_pk_bf16_f32 v154, v56, v57
    v_pk_mul_f32 v[64:65], v[58:59], v[54:55]
    v_pk_mul_f32 v[66:67], v[58:59], v[52:53]
    v_pk_fma_f32 v[58:59], v[56:57], v[54:55], v[66:67]
    v_pk_fma_f32 v[56:57], v[56:57], v[52:53], v[64:65] neg_lo:[0,0,1] neg_hi:[0,0,1]
    v_cvt_pk_bf16_f32 v157, v58, v59
    v_cvt_pk_bf16_f32 v156, v56, v57
    v_pk_mul_f32 v[64:65], v[58:59], v[54:55]
    v_pk_mul_f32 v[66:67], v[58:59], v[52:53]
    v_pk_fma_f32 v[58:59], v[56:57], v[54:55], v[66:67]
    v_pk_fma_f32 v[56:57], v[56:57], v[52:53], v[64:65] neg_lo:[0,0,1] neg_hi:[0,0,1]
    v_cvt_pk_bf16_f32 v159, v58, v59
    v_cvt_pk_bf16_f32 v158, v56, v57
    v_pk_mul_f32 v[64:65], v[58:59], v[54:55]
    v_pk_mul_f32 v[66:67], v[58:59], v[52:53]
    v_pk_fma_f32 v[58:59], v[56:57], v[54:55], v[66:67]
    v_pk_fma_f32 v[56:57], v[56:57], v[52:53], v[64:65] neg_lo:[0,0,1] neg_hi:[0,0,1]
    v_cvt_pk_bf16_f32 v161, v58, v59
    v_cvt_pk_bf16_f32 v160, v56, v57
    s_waitcnt lgkmcnt(0)
    .p2align 3
    v_mfma_f32_16x16x32_bf16 v[136:139], v[100:103], v[68:71], 0
    ds_write_addtid_b32 v144 offset:0
    ds_write_addtid_b32 v145 offset:256
    v_mfma_f32_16x16x32_bf16 v[136:139], v[104:107], v[72:75], v[136:139]
    ds_write_addtid_b32 v146 offset:544
    ds_write_addtid_b32 v147 offset:800
    v_mfma_f32_16x16x32_bf16 v[136:139], v[108:111], v[76:79], v[136:139]
    ds_write_addtid_b32 v148 offset:1088
    ds_write_addtid_b32 v149 offset:1344
    v_mfma_f32_16x16x32_bf16 v[136:139], v[112:115], v[80:83], v[136:139]
    ds_write_addtid_b32 v150 offset:1632
    ds_write_addtid_b32 v151 offset:1888
    v_mfma_f32_16x16x32_bf16 v[136:139], v[116:119], v[84:87], v[136:139]
    ds_write_addtid_b32 v152 offset:2176
    ds_write_addtid_b32 v153 offset:2432
    v_mfma_f32_16x16x32_bf16 v[136:139], v[120:123], v[88:91], v[136:139]
    ds_write_addtid_b32 v154 offset:2720
    ds_write_addtid_b32 v155 offset:2976
    v_mfma_f32_16x16x32_bf16 v[136:139], v[124:127], v[92:95], v[136:139]
    ds_write_addtid_b32 v156 offset:3264
    ds_write_addtid_b32 v157 offset:3520
    v_mfma_f32_16x16x32_bf16 v[136:139], v[128:131], v[96:99], v[136:139]
    ds_write_addtid_b32 v158 offset:3808
    ds_write_addtid_b32 v159 offset:4064
    ds_write_addtid_b32 v160 offset:4352
    ds_write_addtid_b32 v161 offset:4608
    ds_read_b128 v[100:103], v19 offset:0
    ds_read_b128 v[104:107], v19 offset:64
    ds_read_b128 v[108:111], v19 offset:128
    ds_read_b128 v[112:115], v19 offset:192
    ds_read_b128 v[116:119], v19 offset:256
    ds_read_b128 v[120:123], v19 offset:320
    ds_read_b128 v[124:127], v19 offset:384
    ds_read_b128 v[128:131], v19 offset:448
    v_sub_f32 v132, v132, v13
    v_lshl_add_u32 v30, v1, 3, s46
    v_lshl_add_u32 v31, v1, 4, s46
    v_sub_u32 v32, 63, v1
    v_lshl_add_u32 v35, v32, 3, s43
    s_add_u32 s41, s45, 2548
    v_lshl_add_u32 v34, v32, 2, s41
    v_lshrrev_b32 v32, 1, v32
    v_and_b32 v33, 1, v1
    v_mul_u32_u24 v33, 1280, v33
    v_lshl_add_u32 v33, v32, 2, v33
    s_add_u32 s41, s45, 52
    v_add_u32 v33, s41, v33
    v_mov_b32 v36, s46
    ds_write_b128 v25, v[132:135]
    ds_write_b64 v26, v[136:137]
    ds_write_b64 v27, v[138:139]
    ds_read_b128 v[40:43], v31
    ds_read_b32 v47, v31 offset:16
    ds_read_b64 v[44:45], v30 offset:1024
    ds_read_b32 v46, v30 offset:1032
    ds_write_b32 v20, v16
    s_waitcnt lgkmcnt(8)
    .p2align 3
    v_mfma_f32_16x16x32_bf16 v[140:143], v[100:103], v[68:71], 0
    v_mfma_f32_16x16x32_bf16 v[140:143], v[104:107], v[72:75], v[140:143]
    v_mfma_f32_16x16x32_bf16 v[140:143], v[108:111], v[76:79], v[140:143]
    v_mfma_f32_16x16x32_bf16 v[140:143], v[112:115], v[80:83], v[140:143]
    v_mfma_f32_16x16x32_bf16 v[140:143], v[116:119], v[84:87], v[140:143]
    v_mfma_f32_16x16x32_bf16 v[140:143], v[120:123], v[88:91], v[140:143]
    v_mfma_f32_16x16x32_bf16 v[140:143], v[124:127], v[92:95], v[140:143]
    v_mfma_f32_16x16x32_bf16 v[140:143], v[128:131], v[96:99], v[140:143]
    s_waitcnt lgkmcnt(0)
    v_cvt_pk_bf16_f32 v56, v43, v42
    v_cvt_pk_bf16_f32 v57, v41, v40
    v_cvt_pk_bf16_f32 v60, v47, v43
    v_cvt_pk_bf16_f32 v61, v42, v41
    v_cvt_pk_bf16_f32 v64, v46, v45
    v_cvt_pk_bf16_f32 v65, v44, v44
    v_cvt_pk_bf16_f32 v68, v46, v46
    v_cvt_pk_bf16_f32 v69, v45, v44
    ds_write2_b32 v28, v140, v141 offset0:0 offset1:16
    ds_write2_b32 v28, v142, v143 offset0:32 offset1:48
    ds_read_b32 v48, v30 offset:1540
    ds_read_b32 v49, v30 offset:1544
    ds_read_b32 v50, v30 offset:2052
    ds_read_b32 v51, v30 offset:2056
    ds_read_b32 v52, v36 offset:2048
    s_cmp_eq_u32 s47, 0
    s_cbranch_scc1 L_A
    s_mov_b32 s62, 0
W_30:
    ds_read_b32 v10, v3 offset:0
    ds_read_b32 v253, v3 offset:32
    s_add_u32 s62, s62, 1
    s_waitcnt lgkmcnt(0)
    v_cmp_le_u32 vcc, 4, v10
    s_cbranch_vccnz WD_31
    s_sleep 1
    s_cmp_lt_u32 s62, 2097152
    s_cbranch_scc1 W_30
WD_31:
    s_setprio 3
    v_lshlrev_b32 v8, 4, v1
    s_mov_b32 s21, 0xffff0000
    v_cvt_pk_bf16_f32 v58, v48, v49
    v_cvt_pk_bf16_f32 v62, v50, v51
    v_cvt_pk_bf16_f32 v66, v52, v52
    v_mov_b32 v59, v253
    v_mov_b32 v63, v253
    v_mov_b32 v67, v253
    v_mov_b32 v71, v253
    buffer_store_dwordx4 v[56:59], v8, s[8:11], s49 offen offset:0 sc1
    buffer_store_dwordx4 v[60:63], v8, s[8:11], s49 offen offset:1024 sc1
    buffer_store_dwordx4 v[64:67], v8, s[8:11], s49 offen offset:2048 sc1
    buffer_store_dwordx4 v[68:71], v8, s[8:11], s49 offen offset:3072 sc1
    s_mov_b32 s44, s34
    s_mov_b32 s45, s35
    s_and_b32 s41, s2, 7
    s_lshl_b32 s39, s40, 3
    s_add_u32 s39, s39, s41
    s_lshr_b32 s41, s39, 1
    s_mul_i32 s42, s41, 37
    s_lshr_b32 s42, s42, 8
    s_mul_i32 s43, s42, 7
    s_sub_u32 s43, s41, s43
    s_lshl_b32 s51, s42, 3
    s_add_u32 s51, s51, s43
    s_cmp_ge_u32 s43, 3
    s_addc_u32 s51, s51, 0
    s_sub_u32 s41, s42, 7
    s_lshl_b32 s42, s43, 3
    s_add_u32 s42, s42, 3
    s_cmp_ge_u32 s39, 98
    s_cselect_b32 s51, s42, s51
    s_cselect_b32 s50, s41, 0
    s_cselect_b32 s63, 7, 8
    s_cselect_b32 s17, -1, 0
    s_cmp_ge_u32 s39, 126
    s_cbranch_scc1 L_MEND
    s_cmp_eq_u32 s50, 0
    s_cselect_b32 s46, 7340032, 0
    s_mov_b32 s47, 0x20000
    s_lshl_b32 s53, s51, 17
    s_and_b32 s41, s39, 1
    s_lshl_b32 s41, s41, 10
    s_add_u32 s53, s53, s41
    s_lshl_b32 s41, s38, 11
    s_add_u32 s53, s53, s41
    s_mul_i32 s16, s38, 17152
    s_add_u32 s16, s16, 71168
    v_readfirstlane_b32 s26, v253
    s_lshl_b32 s19, s39, 7
    s_lshl_b32 s41, s38, 4
    s_add_u32 s19, s19, s41
    s_add_u32 s19, s19, 524288
    s_mul_i32 s27, s38, 4160
    s_add_u32 s27, s27, 36096
    s_mov_b32 s62, 0
SP_32:
    s_load_dwordx4 s[28:31], s[8:9], s19 glc
    s_add_u32 s62, s62, 1
    s_waitcnt lgkmcnt(0)
    s_cmp_lg_u32 s29, s26
    s_cbranch_scc1 SPN_34
    s_cmp_eq_u32 s31, s26
    s_cbranch_scc1 SPD_33
SPN_34:
    s_cmp_lt_u32 s62, 131072
    s_cbranch_scc1 SP_32
SPD_33:
    s_and_b32 s32, s28, 2047
    s_and_b32 s33, s30, 2047
    s_lshl_b32 s32, s32, 11
    s_lshl_b32 s33, s33, 11
    s_mov_b32 m0, s27
    s_add_u32 s27, s27, 2080
    buffer_load_dwordx4 v8, s[4:7], s32 offen lds
    buffer_load_dwordx4 v8, s[4:7], s32 offen offset:1024 lds
    s_mov_b32 m0, s27
    s_setprio 1
    buffer_load_dwordx4 v8, s[4:7], s33 offen lds
    buffer_load_dwordx4 v8, s[4:7], s33 offen offset:1024 lds
    s_mov_b64 exec, 1
    ds_add_u32 v3, v2 offset:20
    s_mov_b64 exec, -1
    v_and_b32 v15, 7, v1
    v_lshrrev_b32 v12, 4, v1
    v_mul_u32_u24 v14, 8576, v12
    v_bfe_u32 v10, v1, 2, 2
    v_mul_u32_u24 v10, 1056, v10
    v_add_u32 v14, v14, v10
    v_and_b32 v10, 3, v1
    v_lshl_add_u32 v14, v10, 3, v14
    s_lshl_b32 s41, s3, 7
    s_add_u32 s41, s41, 71168
    v_add_u32 v14, s41, v14
    v_mul_u32_u24 v23, 160, v15
    v_lshl_add_u32 v23, v12, 4, v23
    v_add_u32 v23, 61440, v23
    v_mul_u32_u24 v19, 8320, v12
    v_lshl_add_u32 v19, v15, 4, v19
    s_and_b32 s60, s39, 1
    s_lshl_b32 s60, s60, 3
    s_add_u32 s60, s60, s3
    s_mul_i32 s61, s60, 133120
    s_lshl_b32 s41, s51, 7
    s_add_u32 s61, s61, s41
    s_add_u32 s61, s61, 1048576
    s_lshl_b32 s60, s60, 12
    s_mul_i32 s41, s51, 147
    s_lshr_b32 s41, s41, 11
    s_mul_i32 s41, s41, 72
    s_add_u32 s60, s60, s41
    s_lshl_b32 s41, s51, 2
    s_add_u32 s60, s60, s41
    s_add_u32 s60, s60, 589824
    v_lshlrev_b32 v11, 9, v1
    s_lshl_b32 s49, s51, 13
    s_add_u32 s49, s49, 65536
    v_and_b32 v18, 255, v0
    v_lshrrev_b32 v20, 5, v18
    v_and_b32 v21, 31, v18
    v_lshlrev_b32 v18, 3, v18
    s_mov_b32 s42, 0x00ff00ff
    s_mov_b32 s43, 0x00ff00ff
    s_mov_b32 s18, 0x07060501
    s_mov_b32 s19, 0x07060502
    s_mov_b32 s20, 0x07060503
    s_mov_b32 s62, 0
W_35:
    ds_read_b32 v10, v3 offset:36
    s_add_u32 s62, s62, 1
    s_waitcnt lgkmcnt(0)
    v_cmp_le_u32 vcc, 4, v10
    s_cbranch_vccnz WD_36
    s_sleep 1
    s_cmp_lt_u32 s62, 2097152
    s_cbranch_scc1 W_35
WD_36:
    s_mov_b32 s62, 0
W_37:
    ds_read_b32 v10, v3 offset:20
    s_add_u32 s62, s62, 1
    s_waitcnt lgkmcnt(0)
    v_cmp_le_u32 vcc, 4, v10
    s_cbranch_vccnz WD_38
    s_cmp_lt_u32 s62, 2097152
    s_cbranch_scc1 W_37
WD_38:
    s_mov_b32 m0, s16
    s_add_u32 s16, s16, 1056
    buffer_load_dwordx4 v8, s[44:47], s53 offen nt lds
    s_add_u32 s53, s53, 16384
    s_mov_b32 m0, s16
    s_add_u32 s16, s16, 1056
    buffer_load_dwordx4 v8, s[44:47], s53 offen nt lds
    s_add_u32 s53, s53, 16384
    s_mov_b32 m0, s16
    s_add_u32 s16, s16, 1056
    buffer_load_dwordx4 v8, s[44:47], s53 offen nt lds
    s_add_u32 s53, s53, 16384
    s_mov_b32 m0, s16
    s_add_u32 s16, s16, 1056
    buffer_load_dwordx4 v8, s[44:47], s53 offen nt lds
    s_add_u32 s53, s53, 16384
    s_waitcnt vmcnt(4)
    s_mov_b64 exec, 1
    ds_add_u32 v3, v2 offset:60
    s_mov_b64 exec, -1
    s_cmp_lg_u32 s50, 0
    s_cbranch_scc1 L_MEND
    s_mov_b32 m0, s16
    s_add_u32 s16, s16, 1056
    buffer_load_dwordx4 v8, s[44:47], s53 offen nt lds
    s_add_u32 s53, s53, 16384
    s_mov_b32 m0, s16
    s_add_u32 s16, s16, 1056
    buffer_load_dwordx4 v8, s[44:47], s53 offen nt lds
    s_add_u32 s53, s53, 16384
    s_mov_b32 m0, s16
    s_add_u32 s16, s16, 1056
    buffer_load_dwordx4 v8, s[44:47], s53 offen nt lds
    s_add_u32 s53, s53, 16384
    s_mov_b32 m0, s16
    s_add_u32 s16, s16, 1184
    buffer_load_dwordx4 v8, s[44:47], s53 offen nt lds
    s_sub_u32 s53, s53, 106496
    s_mov_b32 m0, s16
    s_add_u32 s16, s16, 1056
    buffer_load_dwordx4 v8, s[44:47], s53 offen nt lds
    s_add_u32 s53, s53, 16384
    s_mov_b32 m0, s16
    s_add_u32 s16, s16, 1056
    buffer_load_dwordx4 v8, s[44:47], s53 offen nt lds
    s_add_u32 s53, s53, 16384
    s_mov_b32 m0, s16
    s_add_u32 s16, s16, 1056
    buffer_load_dwordx4 v8, s[44:47], s53 offen nt lds
    s_add_u32 s53, s53, 16384
    s_mov_b32 m0, s16
    s_add_u32 s16, s16, 1056
    buffer_load_dwordx4 v8, s[44:47], s53 offen nt lds
    s_add_u32 s53, s53, 16384
    s_mov_b32 s62, 0
W_39:
    ds_read_b32 v10, v3 offset:48
    s_add_u32 s62, s62, 1
    s_waitcnt lgkmcnt(0)
    v_cmp_le_u32 vcc, 4, v10
    s_cbranch_vccnz WD_40
    s_cmp_lt_u32 s62, 2097152
    s_cbranch_scc1 W_39
WD_40:
    s_mov_b32 m0, s16
    s_add_u32 s16, s16, 1056
    buffer_load_dwordx4 v8, s[44:47], s53 offen nt lds
    s_add_u32 s53, s53, 16384
    s_mov_b32 m0, s16
    s_add_u32 s16, s16, 1056
    buffer_load_dwordx4 v8, s[44:47], s53 offen nt lds
    s_add_u32 s53, s53, 16384
    s_mov_b32 m0, s16
    s_add_u32 s16, s16, 1056
    buffer_load_dwordx4 v8, s[44:47], s53 offen nt lds
    s_add_u32 s53, s53, 16384
    s_mov_b32 m0, s16
    s_add_u32 s16, s16, 1056
    buffer_load_dwordx4 v8, s[44:47], s53 offen nt lds
    s_add_u32 s53, s53, 16384
    s_waitcnt vmcnt(0)
    s_mov_b64 exec, 1
    ds_add_u32 v3, v2 offset:40
    s_mov_b64 exec, -1
    s_mov_b32 s62, 0
W_41:
    ds_read_b32 v10, v3 offset:40
    s_add_u32 s62, s62, 1
    s_waitcnt lgkmcnt(0)
    v_cmp_le_u32 vcc, 4, v10
    s_cbranch_vccnz WD_42
    s_cmp_lt_u32 s62, 2097152
    s_cbranch_scc1 W_41
WD_42:
    ds_read_b64_tr_b16 v[56:57], v14 offset:0
    ds_read_b64_tr_b16 v[58:59], v14 offset:4224
    ds_read_b64_tr_b16 v[72:73], v14 offset:34304
    ds_read_b64_tr_b16 v[74:75], v14 offset:38528
    ds_read_b64_tr_b16 v[60:61], v14 offset:32
    ds_read_b64_tr_b16 v[62:63], v14 offset:4256
    ds_read_b64_tr_b16 v[76:77], v14 offset:34336
    ds_read_b64_tr_b16 v[78:79], v14 offset:38560
    ds_read_b64_tr_b16 v[64:65], v14 offset:64
    ds_read_b64_tr_b16 v[66:67], v14 offset:4288
    ds_read_b64_tr_b16 v[80:81], v14 offset:34368
    ds_read_b64_tr_b16 v[82:83], v14 offset:38592
    ds_read_b64_tr_b16 v[68:69], v14 offset:96
    ds_read_b64_tr_b16 v[70:71], v14 offset:4320
    ds_read_b64_tr_b16 v[84:85], v14 offset:34400
    ds_read_b64_tr_b16 v[86:87], v14 offset:38624
    v_mov_b32 v27, v253
    v_mov_b32 v31, v253
    v_mov_b32 v35, v253
    v_mov_b32 v39, v253
    s_branch L_FFN2
L_B:
    v_and_b32 v168, 255, v0
    v_lshlrev_b32 v169, 14, v168
    s_lshl_b32 s41, s39, 4
    v_add_u32 v169, s41, v169
    s_mov_b32 s24, 0x07c03800
    s_mov_b32 s25, 0x0fe00038
    s_lshl_b32 s41, s38, 4
    s_lshr_b64 s[24:25], s[24:25], s41
    s_and_b32 s24, s24, 0xffff
    s_mov_b32 s25, 0x1ff0
    s_mov_b32 s26, 0x10001
    s_lshl_b32 s41, s38, 10
    s_add_u32 s41, s41, 149504
    v_lshlrev_b32 v12, 3, v18
    v_add_u32 v14, s41, v8
    v_add_u32 v15, 153600, v8
    v_lshlrev_b32 v10, v17, s24
    v_lshrrev_b32 v10, v12, v10
    v_bfe_u32 v11, v10, 0, 2
    v_lshl_or_b32 v11, v11, 15, v11
    v_and_b32 v11, s26, v11
    v_mul_u32_u24 v80, 0x3f80, v11
    v_bfe_u32 v11, v10, 2, 2
    v_lshl_or_b32 v11, v11, 15, v11
    v_and_b32 v11, s26, v11
    v_mul_u32_u24 v81, 0x3f80, v11
    v_bfe_u32 v11, v10, 4, 2
    v_lshl_or_b32 v11, v11, 15, v11
    v_and_b32 v11, s26, v11
    v_mul_u32_u24 v82, 0x3f80, v11
    v_bfe_u32 v11, v10, 6, 2
    v_lshl_or_b32 v11, v11, 15, v11
    v_and_b32 v11, s26, v11
    v_mul_u32_u24 v83, 0x3f80, v11
    ds_write_b128 v14, v[80:83]
    v_lshlrev_b32 v10, v17, s25
    v_lshrrev_b32 v10, v12, v10
    v_bfe_u32 v11, v10, 0, 2
    v_lshl_or_b32 v11, v11, 15, v11
    v_and_b32 v11, s26, v11
    v_mul_u32_u24 v80, 0x3f80, v11
    v_bfe_u32 v11, v10, 2, 2
    v_lshl_or_b32 v11, v11, 15, v11
    v_and_b32 v11, s26, v11
    v_mul_u32_u24 v81, 0x3f80, v11
    v_bfe_u32 v11, v10, 4, 2
    v_lshl_or_b32 v11, v11, 15, v11
    v_and_b32 v11, s26, v11
    v_mul_u32_u24 v82, 0x3f80, v11
    v_bfe_u32 v11, v10, 6, 2
    v_lshl_or_b32 v11, v11, 15, v11
    v_and_b32 v11, s26, v11
    v_mul_u32_u24 v83, 0x3f80, v11
    ds_write_b128 v15, v[80:83]
    v_lshlrev_b32 v171, 4, v168
    v_add_u32 v171, 104416, v171
    s_lshl_b32 s41, s38, 11
    v_add_u32 v172, s41, v8
    v_add_u32 v173, 141312, v172
    s_mov_b32 s22, 0x05040100
    s_mov_b32 s23, 0x07060302
    s_mov_b32 s26, 12288
    v_bfe_u32 v244, v1, 4, 1
    v_lshrrev_b32 v245, 5, v1
    v_lshlrev_b32 v244, 1, v244
    v_lshl_add_u32 v244, v245, 4, v244
    s_lshl_b32 s41, s38, 2
    v_add_u32 v244, s41, v244
    v_lshlrev_b32 v245, 2, v1
    v_lshrrev_b32 v246, 2, v1
    v_mul_u32_u24 v246, 8160, v246
    v_lshl_add_u32 v246, v1, 3, v246
    s_lshl_b32 s27, s2, 5
    s_add_u32 s27, s27, 4096
    v_add_u32 v247, 141312, v8
    s_waitcnt vmcnt(5)
    s_mov_b64 exec, 1
    ds_add_u32 v3, v2 offset:56
    s_mov_b64 exec, -1
    s_mov_b32 s62, 0
W_43:
    ds_read_b32 v10, v3 offset:56
    ds_read_b128 v[224:227], v247 offset:0
    ds_read_b128 v[228:231], v247 offset:1024
    ds_read_b128 v[232:235], v247 offset:2048
    ds_read_b128 v[236:239], v247 offset:3072
    s_add_u32 s62, s62, 1
    s_waitcnt lgkmcnt(0)
    v_cmp_le_u32 vcc, 4, v10
    s_cbranch_vccnz WD_44
    s_sleep 1
    s_cmp_lt_u32 s62, 2097152
    s_cbranch_scc1 W_43
WD_44:
    v_cmp_gt_u32 vcc, 32, v1
    s_waitcnt vmcnt(1)
    v_dot2_f32_bf16 v240, v208, v224, 0
    v_dot2_f32_bf16 v241, v216, v224, 0
    v_dot2_f32_bf16 v242, v208, v232, 0
    v_dot2_f32_bf16 v243, v216, v232, 0
    v_dot2_f32_bf16 v240, v209, v225, v240
    v_dot2_f32_bf16 v241, v217, v225, v241
    v_dot2_f32_bf16 v242, v209, v233, v242
    v_dot2_f32_bf16 v243, v217, v233, v243
    v_dot2_f32_bf16 v240, v210, v226, v240
    v_dot2_f32_bf16 v241, v218, v226, v241
    v_dot2_f32_bf16 v242, v210, v234, v242
    v_dot2_f32_bf16 v243, v218, v234, v243
    v_dot2_f32_bf16 v240, v211, v227, v240
    v_dot2_f32_bf16 v241, v219, v227, v241
    v_dot2_f32_bf16 v242, v211, v235, v242
    v_dot2_f32_bf16 v243, v219, v235, v243
    v_dot2_f32_bf16 v240, v212, v228, v240
    v_dot2_f32_bf16 v241, v220, v228, v241
    v_dot2_f32_bf16 v242, v212, v236, v242
    v_dot2_f32_bf16 v243, v220, v236, v243
    v_dot2_f32_bf16 v240, v213, v229, v240
    v_dot2_f32_bf16 v241, v221, v229, v241
    v_dot2_f32_bf16 v242, v213, v237, v242
    v_dot2_f32_bf16 v243, v221, v237, v243
    v_dot2_f32_bf16 v240, v214, v230, v240
    v_dot2_f32_bf16 v241, v222, v230, v241
    v_dot2_f32_bf16 v242, v214, v238, v242
    v_dot2_f32_bf16 v243, v222, v238, v243
    v_dot2_f32_bf16 v240, v215, v231, v240
    v_dot2_f32_bf16 v241, v223, v231, v241
    v_dot2_f32_bf16 v242, v215, v239, v242
    v_dot2_f32_bf16 v243, v223, v239, v243
    v_add_u32 v253, 2654435769, v253
    s_nop 0
    v_permlane32_swap_b32 v240, v242
    v_permlane32_swap_b32 v241, v243
    v_add_f32 v240, v240, v242
    v_add_f32 v241, v241, v243
    ds_write_b32 v3, v253 offset:32
    s_nop 0
    v_permlane16_swap_b32 v240, v241
    v_add_f32 v240, v240, v241
    s_nop 1
    v_add_f32_dpp v240, v240, v240 quad_perm:[1,0,3,2] row_mask:0xf bank_mask:0xf
    s_nop 1
    v_add_f32_dpp v240, v240, v240 quad_perm:[2,3,0,1] row_mask:0xf bank_mask:0xf
    s_nop 1
    v_add_f32_dpp v240, v240, v240 row_half_mirror row_mask:0xf bank_mask:0xf
    s_nop 1
    v_add_f32_dpp v240, v240, v240 row_mirror row_mask:0xf bank_mask:0xf
    v_cvt_pk_bf16_f32 v240, v240, v240
    v_and_b32 v241, 0xffff0000, v240
    v_mul_f32 v241, 0xbfb8aa3b, v241
    v_exp_f32 v241, v241
    v_ashrrev_i32 v242, 31, v240
    v_add_f32 v241, 1.0, v241
    v_rcp_f32 v241, v241
    v_or_b32 v242, 0x8000, v242
    v_xor_b32 v240, v240, v242
    v_cvt_pk_bf16_f32 v241, v241, 0
    v_cndmask_b32 v240, v241, v240, vcc
    ds_write_b16 v244, v240 offset:320
    s_mov_b64 exec, 1
    ds_add_rtn_u32 v10, v3, v2 offset:0
    s_mov_b64 exec, 0xff
    ds_read_b32 v252, v245 offset:320
    s_waitcnt lgkmcnt(0)
    v_readfirstlane_b32 s41, v10
    s_cmp_lg_u32 s41, 3
    s_cbranch_scc1 L_NPB
    buffer_store_dwordx2 v[252:253], v246, s[8:11], s27 offen sc1
    s_mov_b64 exec, 1
    ds_add_u32 v3, v2 offset:0
L_NPB:
    s_mov_b64 exec, -1
    s_mov_b32 s62, 0
W_45:
    ds_read_b32 v10, v3 offset:0
    s_add_u32 s62, s62, 1
    s_waitcnt lgkmcnt(0)
    v_cmp_le_u32 vcc, 5, v10
    s_cbranch_vccnz WD_46
    s_sleep 1
    s_cmp_lt_u32 s62, 2097152
    s_cbranch_scc1 W_45
WD_46:
    s_cmp_eq_u32 s41, 3
    s_cbranch_scc1 L_MW
    s_waitcnt vmcnt(0)
L_MW:
    s_waitcnt vmcnt(1)
    s_and_b32 s41, s2, 7
    s_lshl_b32 s24, s40, 3
    s_add_u32 s24, s24, s41
    s_lshr_b32 s41, s24, 1
    s_mul_i32 s42, s41, 37
    s_lshr_b32 s42, s42, 8
    s_mul_i32 s37, s42, 7
    s_sub_u32 s37, s41, s37
    s_lshl_b32 s25, s42, 3
    s_add_u32 s25, s25, s37
    s_cmp_ge_u32 s37, 3
    s_addc_u32 s25, s25, 0
    s_sub_u32 s41, s42, 7
    s_lshl_b32 s42, s37, 3
    s_add_u32 s42, s42, 3
    s_cmp_ge_u32 s24, 98
    s_cselect_b32 s25, s42, s25
    s_cselect_b32 s27, s41, 0
    s_cselect_b32 s36, 7, 8
    s_cselect_b32 s54, 0, 7340032
    s_mov_b32 s55, 0x20000
    s_bitcmp1_b32 s24, 0
    s_cselect_b32 s52, s32, s30
    s_cselect_b32 s53, s33, s31
    s_mul_i32 s41, s38, 1835008
    s_lshl_b32 s42, s25, 7
    s_add_u32 s36, s41, s42
    s_add_u32 s37, s36, 917504
    s_add_u32 s36, s36, 1376256
    v_mul_u32_u24 v76, 7168, v1
    s_mov_b32 s56, s34
    s_mov_b32 s57, s35
    s_cmp_eq_u32 s27, 0
    s_cselect_b32 s58, 7340032, 0
    s_mov_b32 s59, 0x20000
    s_lshl_b32 s27, s25, 17
    s_and_b32 s24, s24, 1
    s_lshl_b32 s24, s24, 10
    s_add_u32 s27, s27, s24
    v_lshrrev_b32 v77, 2, v168
    v_lshlrev_b32 v77, 11, v77
    v_and_b32 v78, 3, v168
    v_lshl_add_u32 v77, v78, 7, v77
    s_cmp_lt_u32 s38, 2
    s_cbranch_scc1 L_C1
    s_mov_b32 s62, 0
W_47:
    ds_read_b32 v10, v3 offset:48
    s_add_u32 s62, s62, 1
    s_waitcnt lgkmcnt(0)
    v_cmp_le_u32 vcc, 2, v10
    s_cbranch_vccnz WD_48
    s_sleep 1
    s_cmp_lt_u32 s62, 2097152
    s_cbranch_scc1 W_47
WD_48:
L_C1:
    s_cmp_eq_u32 s19, 0
    s_cbranch_scc1 U_49
    buffer_load_dwordx4 v[176:179], v169, s[4:7], 0 offen offset:0
U_49:
    s_cmp_eq_u32 s19, 1
    s_cbranch_scc1 U_50
    buffer_load_dwordx4 v[180:183], v169, s[4:7], 0 offen offset:2048
U_50:
    s_cmp_eq_u32 s19, 2
    s_cbranch_scc1 U_51
    buffer_load_dwordx4 v[184:187], v169, s[4:7], s16 offen offset:0
U_51:
    s_cmp_eq_u32 s19, 3
    s_cbranch_scc1 U_52
    buffer_load_dwordx4 v[188:191], v169, s[4:7], s16 offen offset:2048
U_52:
    s_cmp_eq_u32 s19, 4
    s_cbranch_scc1 U_53
    buffer_load_dwordx4 v[192:195], v169, s[4:7], s17 offen offset:0
U_53:
    s_cmp_eq_u32 s19, 5
    s_cbranch_scc1 U_54
    buffer_load_dwordx4 v[196:199], v169, s[4:7], s17 offen offset:2048
U_54:
    s_cmp_eq_u32 s19, 6
    s_cbranch_scc1 U_55
    buffer_load_dwordx4 v[200:203], v169, s[4:7], s18 offen offset:0
U_55:
    s_cmp_eq_u32 s19, 7
    s_cbranch_scc1 U_56
    buffer_load_dwordx4 v[204:207], v169, s[4:7], s18 offen offset:2048
U_56:
    s_mov_b64 exec, 1
    ds_add_u32 v3, v2 offset:4
    s_mov_b64 exec, -1
    s_mov_b32 s62, 0
W_57:
    ds_read_b32 v10, v3 offset:4
    s_add_u32 s62, s62, 1
    s_waitcnt lgkmcnt(0)
    v_cmp_le_u32 vcc, 2, v10
    s_cbranch_vccnz WD_58
    s_sleep 1
    s_cmp_lt_u32 s62, 2097152
    s_cbranch_scc1 W_57
WD_58:
    s_mov_b32 s62, 0
    buffer_load_dwordx4 v[32:35], v172, s[8:11], s26 offen sc1
    buffer_load_dwordx4 v[36:39], v172, s[8:11], s26 offen offset:1024 sc1
    s_mov_b64 exec, 1
    ds_add_u32 v3, v2 offset:48
    s_mov_b64 exec, -1
    s_waitcnt vmcnt(2)
    v_perm_b32 v208, v180, v176, s22
    v_perm_b32 v209, v188, v184, s22
    v_perm_b32 v210, v196, v192, s22
    v_perm_b32 v211, v204, v200, s22
    v_perm_b32 v212, v180, v176, s23
    v_perm_b32 v213, v188, v184, s23
    v_perm_b32 v214, v196, v192, s23
    v_perm_b32 v215, v204, v200, s23
    ds_write_b128 v171, v[208:211] offset:0
    ds_write_b128 v171, v[212:215] offset:4672
    v_perm_b32 v216, v181, v177, s22
    v_perm_b32 v217, v189, v185, s22
    v_perm_b32 v218, v197, v193, s22
    v_perm_b32 v219, v205, v201, s22
    v_perm_b32 v220, v181, v177, s23
    v_perm_b32 v221, v189, v185, s23
    v_perm_b32 v222, v197, v193, s23
    v_perm_b32 v223, v205, v201, s23
    ds_write_b128 v171, v[216:219] offset:9344
    ds_write_b128 v171, v[220:223] offset:14016
    v_perm_b32 v224, v182, v178, s22
    v_perm_b32 v225, v190, v186, s22
    v_perm_b32 v226, v198, v194, s22
    v_perm_b32 v227, v206, v202, s22
    v_perm_b32 v228, v182, v178, s23
    v_perm_b32 v229, v190, v186, s23
    v_perm_b32 v230, v198, v194, s23
    v_perm_b32 v231, v206, v202, s23
    ds_write_b128 v171, v[224:227] offset:18688
    ds_write_b128 v171, v[228:231] offset:23360
    v_perm_b32 v232, v183, v179, s22
    v_perm_b32 v233, v191, v187, s22
    v_perm_b32 v234, v199, v195, s22
    v_perm_b32 v235, v207, v203, s22
    v_perm_b32 v236, v183, v179, s23
    v_perm_b32 v237, v191, v187, s23
    v_perm_b32 v238, v199, v195, s23
    v_perm_b32 v239, v207, v203, s23
    ds_write_b128 v171, v[232:235] offset:28032
    ds_write_b128 v171, v[236:239] offset:32704
    s_waitcnt vmcnt(0)
    s_branch PC_61
P_59:
    buffer_load_dwordx4 v[32:35], v172, s[8:11], s26 offen sc1
    buffer_load_dwordx4 v[36:39], v172, s[8:11], s26 offen offset:1024 sc1
    s_waitcnt vmcnt(0)
PC_61:
    s_add_u32 s62, s62, 1
    v_xor_b32 v10, v253, v33
    v_bitop3_b32 v10, v35, v253, v10 bitop3:0xbe
    v_bitop3_b32 v10, v37, v253, v10 bitop3:0xbe
    v_bitop3_b32 v10, v39, v253, v10 bitop3:0xbe
    v_cmp_ne_u32 vcc, 0, v10
    v_lshlrev_b32 v48, 16, v32
    v_and_b32 v49, s48, v32
    v_lshlrev_b32 v50, 16, v34
    v_and_b32 v51, s48, v34
    v_lshlrev_b32 v52, 16, v36
    v_and_b32 v53, s48, v36
    v_lshlrev_b32 v54, 16, v38
    v_and_b32 v55, s48, v38
    s_cbranch_vccz PD_60
    s_sleep 4
    s_cmp_lt_u32 s62, 32768
    s_cbranch_scc1 P_59
PD_60:
    ds_write_b128 v173, v[48:51]
    ds_write_b128 v173, v[52:55] offset:1024
    s_lshr_b32 s41, s38, 1
    s_mul_i32 s41, s41, 36
    v_mov_b32 v10, s41
    s_mov_b64 exec, 1
    ds_add_u32 v10, v2 offset:8
    s_mov_b64 exec, -1
    s_mov_b32 s62, 0
W_62:
    ds_read_b32 v10, v3 offset:48
    s_add_u32 s62, s62, 1
    s_waitcnt lgkmcnt(0)
    v_cmp_le_u32 vcc, 4, v10
    s_cbranch_vccnz WD_63
    s_sleep 1
    s_cmp_lt_u32 s62, 2097152
    s_cbranch_scc1 W_62
WD_63:
    buffer_load_dword v0, v76, s[52:55], s36 offen
    s_setprio 0
    v_readfirstlane_b32 s26, v253
    s_add_u32 s29, s49, 4092
    s_mov_b32 s62, 0
SP_64:
    s_load_dword s28, s[8:9], s29 glc
    s_add_u32 s62, s62, 1
    s_waitcnt lgkmcnt(0)
    s_cmp_eq_u32 s28, s26
    s_cbranch_scc1 SPD_65
SPN_66:
    s_sleep 1
    s_cmp_lt_u32 s62, 131072
    s_cbranch_scc1 SP_64
SPD_65:
    s_mov_b32 s62, 0
    buffer_load_dwordx4 v[56:59], v8, s[8:11], s49 offen offset:0 sc1
    buffer_load_dwordx4 v[60:63], v8, s[8:11], s49 offen offset:1024 sc1
    buffer_load_dwordx4 v[64:67], v8, s[8:11], s49 offen offset:2048 sc1
    buffer_load_dwordx4 v[68:71], v8, s[8:11], s49 offen offset:3072 sc1
    v_sub_u32 v32, 63, v1
    v_lshl_add_u32 v35, v32, 3, s43
    s_add_u32 s41, s45, 2548
    v_lshl_add_u32 v34, v32, 2, s41
    v_lshrrev_b32 v32, 1, v32
    v_and_b32 v33, 1, v1
    v_mul_u32_u24 v33, 1280, v33
    v_lshl_add_u32 v33, v32, 2, v33
    s_add_u32 s41, s45, 52
    v_add_u32 v33, s41, v33
    ds_write_b32 v20, v16
    s_waitcnt vmcnt(0)
    s_branch PC_69
P_67:
    buffer_load_dwordx4 v[56:59], v8, s[8:11], s49 offen offset:0 sc1
    buffer_load_dwordx4 v[60:63], v8, s[8:11], s49 offen offset:1024 sc1
    buffer_load_dwordx4 v[64:67], v8, s[8:11], s49 offen offset:2048 sc1
    buffer_load_dwordx4 v[68:71], v8, s[8:11], s49 offen offset:3072 sc1
    s_waitcnt vmcnt(0)
PC_69:
    s_add_u32 s62, s62, 1
    v_xor_b32 v12, v253, v59
    v_bitop3_b32 v12, v63, v253, v12 bitop3:0xbe
    v_bitop3_b32 v12, v67, v253, v12 bitop3:0xbe
    v_bitop3_b32 v12, v71, v253, v12 bitop3:0xbe
    v_cmp_ne_u32 vcc, 0, v12
    s_cbranch_vccz PD_68
    s_sleep 4
    s_cmp_lt_u32 s62, 32768
    s_cbranch_scc1 P_67
PD_68:
L_A:
    v_and_b32 v72, s48, v68
    v_lshrrev_b32 v73, 16, v57
    v_add_u32 v163, 512, v162
    ds_write_b64 v35, v[56:57] offset:576
    ds_write_b64 v35, v[60:61] offset:1792
    ds_write_b64 v35, v[64:65] offset:64
    ds_write_b64 v35, v[68:69] offset:1280
    s_mov_b64 exec, 1
    ds_write_b32 v35, v73 offset:1800
    s_mov_b32 exec_lo, 0
    s_brev_b32 exec_hi, 1
    ds_write2_b32 v35, v72, v68 offset0:14 offset1:15
    ds_write_b32 v35, v68 offset:1276
    s_mov_b64 exec, -1
    s_cmp_ge_u32 s3, 4
    s_cbranch_scc1 L_P2
    s_waitcnt lgkmcnt(7)
    v_cvt_pk_bf16_f32 v58, v48, v49
    v_cvt_pk_bf16_f32 v62, v50, v51
    v_cvt_pk_bf16_f32 v66, v52, v52
L_P2:
    ds_write2_b32 v33, v58, v58 offset0:0 offset1:81
    ds_write2_b32 v33, v58, v58 offset0:162 offset1:243
    ds_write2_b32 v34, v62, v62 offset0:0 offset1:81
    ds_write2_b32 v34, v62, v62 offset0:162 offset1:243
    v_and_b32 v80, v66, v164
    v_and_b32 v81, v66, v165
    v_and_b32 v82, v66, v166
    v_and_b32 v83, v66, v167
    s_lshl_b32 s41, s3, 2
    v_mov_b32 v8, s41
    v_lshlrev_b32 v9, 4, v1
    v_add_u32 v9, 149504, v9
    ds_read2_b32 v[12:13], v163 offset0:128 offset1:129
    ds_read2_b32 v[14:15], v163 offset0:130 offset1:131
    ds_read2_b32 v[16:17], v163 offset0:112 offset1:113
    ds_read2_b32 v[18:19], v163 offset0:114 offset1:115
    ds_read2_b32 v[44:45], v163 offset0:0 offset1:1
    ds_read2_b32 v[46:47], v163 offset0:2 offset1:3
    ds_read2_b32 v[48:49], v162 offset0:112 offset1:113
    ds_read2_b32 v[50:51], v162 offset0:114 offset1:115
    ds_read2_b32 v[76:77], v162 offset0:0 offset1:1
    ds_read2_b32 v[78:79], v162 offset0:2 offset1:3
    v_mov_b32 v11, v170
    s_waitcnt vmcnt(0)
    v_mov_b32 v0, v162
    s_cmp_lg_u32 s3, 4
    s_cbranch_scc1 L_NMK
    s_and_b32 s41, s2, 7
    s_lshl_b32 s33, s40, 3
    s_add_u32 s33, s33, s41
    s_lshl_b32 s33, s33, 7
    s_add_u32 s33, s33, 524288
    v_readfirstlane_b32 s32, v253
    s_mov_b32 s62, 0
SP_70:
    s_load_dwordx16 s[16:31], s[8:9], s33 glc
    s_add_u32 s62, s62, 1
    s_waitcnt lgkmcnt(0)
    s_cmp_lg_u32 s17, s32
    s_cbranch_scc1 SPN_72
    s_cmp_lg_u32 s19, s32
    s_cbranch_scc1 SPN_72
    s_cmp_lg_u32 s21, s32
    s_cbranch_scc1 SPN_72
    s_cmp_lg_u32 s23, s32
    s_cbranch_scc1 SPN_72
    s_cmp_lg_u32 s25, s32
    s_cbranch_scc1 SPN_72
    s_cmp_lg_u32 s27, s32
    s_cbranch_scc1 SPN_72
    s_cmp_lg_u32 s29, s32
    s_cbranch_scc1 SPN_72
    s_cmp_eq_u32 s31, s32
    s_cbranch_scc1 SPD_71
SPN_72:
    s_sleep 4
    s_cmp_lt_u32 s62, 131072
    s_cbranch_scc1 SP_70
SPD_71:
    v_writelane_b32 v148, s16, 0
    v_writelane_b32 v148, s18, 1
    v_writelane_b32 v148, s20, 2
    v_writelane_b32 v148, s22, 3
    v_writelane_b32 v148, s24, 4
    v_writelane_b32 v148, s26, 5
    v_writelane_b32 v148, s28, 6
    v_writelane_b32 v148, s30, 7
    v_lshlrev_b32 v149, 2, v1
    v_and_b32 v150, 0xfc, v148
    v_and_b32 v151, 3, v148
    v_bfe_u32 v152, v148, 8, 3
    v_lshl_add_u32 v151, v151, 3, v152
    v_lshlrev_b32 v151, v151, v2
    s_mov_b64 exec, 0xff
    ds_or_b32 v150, v151 offset:640
    ds_write_b32 v149, v148 offset:256
    s_mov_b64 exec, -1
L_NMK:
    s_mov_b32 s62, 0
W_73:
    ds_read_b32 v10, v3 offset:8
    s_add_u32 s62, s62, 1
    s_waitcnt lgkmcnt(0)
    v_cmp_le_u32 vcc, 2, v10
    s_cbranch_vccnz WD_74
    s_sleep 1
    s_cmp_lt_u32 s62, 2097152
    s_cbranch_scc1 W_73
WD_74:
    s_cmp_lt_u32 s3, 4
    s_cbranch_scc1 L_CP
    s_setprio 0
L_CP:
    .p2align 3
    ds_read_b64 v[146:147], v5 offset:0
    ds_read_b64 v[150:151], v5 offset:512
    ds_read_b128 v[152:155], v4 offset:448
    ds_read_b128 v[156:159], v4 offset:384
    ds_read_b128 v[160:163], v4 offset:320
    ds_read2_b32 v[20:21], v0 offset0:224 offset1:225
    ds_read2_b32 v[22:23], v0 offset0:226 offset1:227
    ds_read2_b32 v[52:53], v0 offset0:96 offset1:97
    ds_read2_b32 v[54:55], v0 offset0:98 offset1:99
    ds_read_b128 v[164:167], v4 offset:256
    ds_read2_b32 v[24:25], v0 offset0:208 offset1:209
    ds_read2_b32 v[26:27], v0 offset0:210 offset1:211
    s_waitcnt lgkmcnt(11)
    v_lshlrev_b32 v144, 16, v146
    v_and_b32 v145, s48, v146
    v_lshlrev_b32 v146, 16, v147
    v_and_b32 v147, s48, v147
    s_waitcnt lgkmcnt(9)
    s_nop 0
    v_mfma_f32_16x16x32_bf16 v[168:171], v[12:15], v[152:155], v[144:147]
    ds_read2_b32 v[56:57], v0 offset0:80 offset1:81
    ds_read2_b32 v[58:59], v0 offset0:82 offset1:83
    v_lshlrev_b32 v148, 16, v150
    v_and_b32 v149, s48, v150
    v_lshlrev_b32 v150, 16, v151
    v_and_b32 v151, s48, v151
    s_nop 1
    v_mfma_f32_16x16x32_bf16 v[172:175], v[44:47], v[152:155], v[148:151]
    ds_read_b128 v[176:179], v4 offset:192
    ds_read2_b32 v[28:29], v0 offset0:192 offset1:193
    ds_read2_b32 v[30:31], v0 offset0:194 offset1:195
    s_waitcnt lgkmcnt(13)
    v_mfma_f32_16x16x32_bf16 v[168:171], v[16:19], v[156:159], v[168:171]
    v_mfma_f32_16x16x32_bf16 v[172:175], v[48:51], v[156:159], v[172:175]
    s_waitcnt lgkmcnt(10)
    v_mfma_f32_16x16x32_bf16 v[168:171], v[20:23], v[160:163], v[168:171]
    ds_read2_b32 v[60:61], v0 offset0:64 offset1:65
    ds_read2_b32 v[62:63], v0 offset0:66 offset1:67
    ds_read_b128 v[180:183], v4 offset:128
    s_waitcnt lgkmcnt(11)
    v_mfma_f32_16x16x32_bf16 v[172:175], v[52:55], v[160:163], v[172:175]
    ds_read2_b32 v[32:33], v0 offset0:176 offset1:177
    ds_read2_b32 v[34:35], v0 offset0:178 offset1:179
    s_waitcnt lgkmcnt(10)
    v_mfma_f32_16x16x32_bf16 v[168:171], v[24:27], v[164:167], v[168:171]
    ds_read2_b32 v[64:65], v0 offset0:48 offset1:49
    ds_read2_b32 v[66:67], v0 offset0:50 offset1:51
    ds_read_b128 v[184:187], v4 offset:64
    s_waitcnt lgkmcnt(11)
    v_mfma_f32_16x16x32_bf16 v[172:175], v[56:59], v[164:167], v[172:175]
    ds_read2_b32 v[36:37], v0 offset0:160 offset1:161
    ds_read2_b32 v[38:39], v0 offset0:162 offset1:163
    ds_read_b64 v[190:191], v5 offset:1024
    s_waitcnt lgkmcnt(11)
    v_mfma_f32_16x16x32_bf16 v[168:171], v[28:31], v[176:179], v[168:171]
    ds_read2_b32 v[68:69], v0 offset0:32 offset1:33
    ds_read2_b32 v[70:71], v0 offset0:34 offset1:35
    ds_read_b128 v[192:195], v4 offset:0
    s_waitcnt lgkmcnt(12)
    v_mfma_f32_16x16x32_bf16 v[172:175], v[60:63], v[176:179], v[172:175]
    ds_read2_b32 v[40:41], v0 offset0:144 offset1:145
    ds_read2_b32 v[42:43], v0 offset0:146 offset1:147
    s_waitcnt lgkmcnt(11)
    v_mfma_f32_16x16x32_bf16 v[168:171], v[32:35], v[180:183], v[168:171]
    ds_read_b128 v[196:199], v6 offset:0
    ds_read2_b32 v[72:73], v0 offset0:16 offset1:17
    ds_read2_b32 v[74:75], v0 offset0:18 offset1:19
    s_waitcnt lgkmcnt(12)
    v_mfma_f32_16x16x32_bf16 v[172:175], v[64:67], v[180:183], v[172:175]
    ds_read_b128 v[200:203], v4 offset:960
    ds_read_b128 v[204:207], v4 offset:896
    s_waitcnt lgkmcnt(11)
    v_mfma_f32_16x16x32_bf16 v[168:171], v[36:39], v[184:187], v[168:171]
    ds_read_b128 v[208:211], v4 offset:832
    s_waitcnt lgkmcnt(9)
    v_mfma_f32_16x16x32_bf16 v[172:175], v[68:71], v[184:187], v[172:175]
    v_lshlrev_b32 v188, 16, v190
    v_and_b32 v189, s48, v190
    s_waitcnt lgkmcnt(6)
    v_mfma_f32_16x16x32_bf16 v[168:171], v[40:43], v[192:195], v[168:171]
    v_lshlrev_b32 v190, 16, v191
    v_and_b32 v191, s48, v191
    s_waitcnt lgkmcnt(3)
    v_mfma_f32_16x16x32_bf16 v[172:175], v[72:75], v[192:195], v[172:175]
    ds_read_b128 v[212:215], v4 offset:768
    s_waitcnt lgkmcnt(3)
    v_mfma_f32_16x16x32_bf16 v[172:175], v[12:15], v[200:203], v[172:175]
    ds_read_b128 v[216:219], v4 offset:704
    v_mfma_f32_16x16x32_bf16 v[220:223], v[44:47], v[200:203], v[188:191]
    ds_read_b128 v[224:227], v4 offset:640
    s_waitcnt lgkmcnt(4)
    v_mfma_f32_16x16x32_bf16 v[172:175], v[16:19], v[204:207], v[172:175]
    ds_read_b128 v[228:231], v4 offset:576
    v_mfma_f32_16x16x32_bf16 v[220:223], v[48:51], v[204:207], v[220:223]
    v_fma_f32 v168, -v196, v168, v144
    v_fma_f32 v169, -v197, v169, v145
    s_waitcnt lgkmcnt(4)
    v_mfma_f32_16x16x32_bf16 v[172:175], v[20:23], v[208:211], v[172:175]
    v_fma_f32 v170, -v198, v170, v146
    v_fma_f32 v171, -v199, v171, v147
    v_mfma_f32_16x16x32_bf16 v[220:223], v[52:55], v[208:211], v[220:223]
    v_cvt_pk_bf16_f32 v168, v168, v169
    v_cvt_pk_bf16_f32 v169, v170, v171
    s_waitcnt lgkmcnt(3)
    v_mfma_f32_16x16x32_bf16 v[172:175], v[24:27], v[212:215], v[172:175]
    ds_write_b64 v7, v[168:169] offset:0
    ds_write_b32 v8, v2 offset:384
    v_mfma_f32_16x16x32_bf16 v[220:223], v[56:59], v[212:215], v[220:223]
    ds_read_b128 v[232:235], v4 offset:512
    s_waitcnt lgkmcnt(4)
    v_mfma_f32_16x16x32_bf16 v[172:175], v[28:31], v[216:219], v[172:175]
    ds_read_b128 v[236:239], v6 offset:1024
    v_mfma_f32_16x16x32_bf16 v[220:223], v[60:63], v[216:219], v[220:223]
    ds_read_b128 v[240:243], v4 offset:448
    v_mfma_f32_16x16x32_bf16 v[172:175], v[32:35], v[224:227], v[172:175]
    ds_read_b128 v[124:127], v9 offset:0
    v_mfma_f32_16x16x32_bf16 v[220:223], v[64:67], v[224:227], v[220:223]
    ds_read_b128 v[128:131], v9 offset:1024
    s_waitcnt lgkmcnt(7)
    v_mfma_f32_16x16x32_bf16 v[172:175], v[36:39], v[228:231], v[172:175]
    ds_read_b64 v[246:247], v5 offset:1536
    v_mfma_f32_16x16x32_bf16 v[220:223], v[68:71], v[228:231], v[220:223]
    ds_read_b128 v[132:135], v9 offset:2048
    s_waitcnt lgkmcnt(6)
    v_mfma_f32_16x16x32_bf16 v[172:175], v[40:43], v[232:235], v[172:175]
    ds_read_b128 v[248:251], v4 offset:432
    v_mfma_f32_16x16x32_bf16 v[220:223], v[72:75], v[232:235], v[220:223]
    ds_read_b128 v[252:255], v4 offset:1472
    s_waitcnt lgkmcnt(5)
    v_mfma_f32_16x16x32_bf16 v[152:155], v[240:243], v[124:127], 0
    ds_read_b128 v[156:159], v4 offset:1408
    s_waitcnt lgkmcnt(5)
    v_mfma_f32_16x16x32_bf16 v[160:163], v[240:243], v[128:131], 0
    ds_read_b128 v[164:167], v4 offset:1344
    s_waitcnt lgkmcnt(4)
    v_mfma_f32_16x16x32_bf16 v[176:179], v[240:243], v[132:135], 0
    v_lshlrev_b32 v244, 16, v246
    v_and_b32 v245, s48, v246
    s_waitcnt lgkmcnt(3)
    v_mfma_f32_16x16x32_bf16 v[180:183], v[248:251], v[128:131], 0
    v_lshlrev_b32 v246, 16, v247
    v_and_b32 v247, s48, v247
    v_mfma_f32_16x16x32_bf16 v[220:223], v[76:79], v[240:243], v[220:223]
    ds_read_b128 v[184:187], v4 offset:1280
    s_waitcnt lgkmcnt(3)
    v_mfma_f32_16x16x32_bf16 v[220:223], v[12:15], v[252:255], v[220:223]
    v_fma_f32 v172, -v236, v172, v148
    v_fma_f32 v173, -v237, v173, v149
    v_mfma_f32_16x16x32_bf16 v[192:195], v[44:47], v[252:255], v[244:247]
    ds_read_b128 v[200:203], v4 offset:1216
    s_waitcnt lgkmcnt(3)
    v_mfma_f32_16x16x32_bf16 v[220:223], v[16:19], v[156:159], v[220:223]
    v_fma_f32 v174, -v238, v174, v150
    v_fma_f32 v175, -v239, v175, v151
    v_mfma_f32_16x16x32_bf16 v[192:195], v[48:51], v[156:159], v[192:195]
    ds_read_b128 v[204:207], v4 offset:1152
    s_waitcnt lgkmcnt(3)
    v_mfma_f32_16x16x32_bf16 v[220:223], v[20:23], v[164:167], v[220:223]
    v_cvt_pk_bf16_f32 v172, v172, v173
    v_cvt_pk_bf16_f32 v173, v174, v175
    v_mfma_f32_16x16x32_bf16 v[192:195], v[52:55], v[164:167], v[192:195]
    ds_read_b128 v[144:147], v4 offset:1088
    s_waitcnt lgkmcnt(3)
    v_mfma_f32_16x16x32_bf16 v[220:223], v[24:27], v[184:187], v[220:223]
    ds_write_b64 v7, v[172:173] offset:512
    ds_write_b32 v8, v2 offset:416
    v_mfma_f32_16x16x32_bf16 v[192:195], v[56:59], v[184:187], v[192:195]
    ds_read_b128 v[196:199], v4 offset:1024
    s_waitcnt lgkmcnt(5)
    v_mfma_f32_16x16x32_bf16 v[220:223], v[28:31], v[200:203], v[220:223]
    v_cvt_pk_bf16_f32 v208, v152, v160
    v_cvt_pk_bf16_f32 v209, v153, v161
    v_mfma_f32_16x16x32_bf16 v[192:195], v[60:63], v[200:203], v[192:195]
    ds_read_b128 v[84:87], v11 offset:128
    s_waitcnt lgkmcnt(5)
    v_mfma_f32_16x16x32_bf16 v[220:223], v[32:35], v[204:207], v[220:223]
    ds_read_b128 v[88:91], v11 offset:1408
    v_mfma_f32_16x16x32_bf16 v[192:195], v[64:67], v[204:207], v[192:195]
    ds_read_b128 v[168:171], v4 offset:960
    s_waitcnt lgkmcnt(6)
    v_mfma_f32_16x16x32_bf16 v[220:223], v[36:39], v[144:147], v[220:223]
    ds_read_b128 v[212:215], v6 offset:2048
    v_mfma_f32_16x16x32_bf16 v[192:195], v[68:71], v[144:147], v[192:195]
    v_cvt_pk_bf16_f32 v210, v154, v162
    v_cvt_pk_bf16_f32 v211, v155, v163
    s_waitcnt lgkmcnt(4)
    v_mfma_f32_16x16x32_bf16 v[220:223], v[40:43], v[196:199], v[220:223]
    ds_read_b128 v[216:219], v4 offset:944
    v_mfma_f32_16x16x32_bf16 v[192:195], v[72:75], v[196:199], v[192:195]
    v_cvt_pk_bf16_f32 v224, v176, v180
    v_cvt_pk_bf16_f32 v225, v177, v181
    s_waitcnt lgkmcnt(4)
    v_mfma_f32_16x16x32_bf16 v[220:223], v[208:211], v[84:87], v[220:223]
    ds_read_b128 v[228:231], v4 offset:1984
    v_cvt_pk_bf16_f32 v226, v178, v182
    v_cvt_pk_bf16_f32 v227, v179, v183
    s_waitcnt lgkmcnt(4)
    s_nop 0
    v_mfma_f32_16x16x32_bf16 v[220:223], v[224:227], v[88:91], v[220:223]
    ds_read_b128 v[232:235], v4 offset:1920
    s_waitcnt lgkmcnt(4)
    v_mfma_f32_16x16x32_bf16 v[248:251], v[168:171], v[124:127], 0
    ds_read_b128 v[240:243], v4 offset:1856
    v_mfma_f32_16x16x32_bf16 v[252:255], v[168:171], v[128:131], 0
    ds_read_b128 v[148:151], v4 offset:1792
    v_mfma_f32_16x16x32_bf16 v[236:239], v[168:171], v[132:135], 0
    ds_read_b128 v[156:159], v4 offset:1728
    s_waitcnt lgkmcnt(5)
    v_mfma_f32_16x16x32_bf16 v[164:167], v[216:219], v[128:131], 0
    ds_read_b128 v[172:175], v4 offset:1664
    v_mfma_f32_16x16x32_bf16 v[192:195], v[76:79], v[168:171], v[192:195]
    v_fma_f32 v220, -v212, v220, v188
    v_fma_f32 v221, -v213, v221, v189
    s_waitcnt lgkmcnt(5)
    v_mfma_f32_16x16x32_bf16 v[192:195], v[12:15], v[228:231], v[192:195]
    v_fma_f32 v222, -v214, v222, v190
    v_fma_f32 v223, -v215, v223, v191
    v_mfma_f32_16x16x32_bf16 v[184:187], v[44:47], v[228:231], 0
    v_cvt_pk_bf16_f32 v220, v220, v221
    v_cvt_pk_bf16_f32 v221, v222, v223
    s_waitcnt lgkmcnt(3)
    v_mfma_f32_16x16x32_bf16 v[192:195], v[16:19], v[232:235], v[192:195]
    ds_write_b64 v7, v[220:221] offset:1024
    ds_write_b32 v8, v2 offset:448
    v_mfma_f32_16x16x32_bf16 v[184:187], v[48:51], v[232:235], v[184:187]
    v_cvt_pk_bf16_f32 v200, v248, v252
    v_cvt_pk_bf16_f32 v201, v249, v253
    v_mfma_f32_16x16x32_bf16 v[192:195], v[20:23], v[240:243], v[192:195]
    v_cvt_pk_bf16_f32 v202, v250, v254
    v_cvt_pk_bf16_f32 v203, v251, v255
    v_mfma_f32_16x16x32_bf16 v[184:187], v[52:55], v[240:243], v[184:187]
    ds_read_b128 v[204:207], v4 offset:1600
    s_waitcnt lgkmcnt(3)
    v_mfma_f32_16x16x32_bf16 v[192:195], v[24:27], v[148:151], v[192:195]
    v_cvt_pk_bf16_f32 v144, v236, v164
    v_cvt_pk_bf16_f32 v145, v237, v165
    v_mfma_f32_16x16x32_bf16 v[184:187], v[56:59], v[148:151], v[184:187]
    ds_read_b128 v[152:155], v4 offset:1536
    v_mfma_f32_16x16x32_bf16 v[192:195], v[28:31], v[156:159], v[192:195]
    v_cvt_pk_bf16_f32 v146, v238, v166
    v_cvt_pk_bf16_f32 v147, v239, v167
    v_mfma_f32_16x16x32_bf16 v[184:187], v[60:63], v[156:159], v[184:187]
    ds_read_b128 v[92:95], v11 offset:64
    v_mfma_f32_16x16x32_bf16 v[192:195], v[32:35], v[172:175], v[192:195]
    ds_read_b32 v10, v3 offset:44
    v_mfma_f32_16x16x32_bf16 v[184:187], v[64:67], v[172:175], v[184:187]
    ds_read_b128 v[96:99], v11 offset:1344
    s_waitcnt lgkmcnt(4)
    v_mfma_f32_16x16x32_bf16 v[192:195], v[36:39], v[204:207], v[192:195]
    ds_read_b128 v[160:163], v4 offset:1472
    v_mfma_f32_16x16x32_bf16 v[184:187], v[68:71], v[204:207], v[184:187]
    ds_read_b128 v[196:199], v6 offset:3072
    s_waitcnt lgkmcnt(5)
    v_mfma_f32_16x16x32_bf16 v[192:195], v[40:43], v[152:155], v[192:195]
    ds_read_b128 v[176:179], v4 offset:1456
    v_mfma_f32_16x16x32_bf16 v[184:187], v[72:75], v[152:155], v[184:187]
    s_waitcnt lgkmcnt(4)
    v_cmp_le_u32 vcc, 2, v10
    v_mfma_f32_16x16x32_bf16 v[192:195], v[208:211], v[92:95], v[192:195]
    s_waitcnt lgkmcnt(3)
    v_mfma_f32_16x16x32_bf16 v[192:195], v[224:227], v[96:99], v[192:195]
    s_cbranch_vccnz L_GATE_OK
    s_mov_b32 s62, 0
L_GATE:
    ds_read_b32 v10, v3 offset:44
    s_add_u32 s62, s62, 1
    s_waitcnt lgkmcnt(0)
    v_cmp_le_u32 vcc, 2, v10
    s_cbranch_vccnz L_GATE_OK
    s_sleep 1
    s_cmp_lt_u32 s62, 2097152
    s_cbranch_scc1 L_GATE
L_GATE_OK:
    ds_read_b64 v[182:183], v5 offset:2560
    v_mfma_f32_16x16x32_bf16 v[192:195], v[200:203], v[84:87], v[192:195]
    ds_read_b128 v[216:219], v4 offset:448
    v_mfma_f32_16x16x32_bf16 v[192:195], v[144:147], v[88:91], v[192:195]
    ds_read_b128 v[136:139], v9 offset:3072
    s_waitcnt lgkmcnt(4)
    v_mfma_f32_16x16x32_bf16 v[168:171], v[160:163], v[124:127], 0
    ds_read_b128 v[188:191], v4 offset:432
    v_mfma_f32_16x16x32_bf16 v[212:215], v[160:163], v[128:131], 0
    ds_read_b128 v[140:143], v9 offset:4096
    v_mfma_f32_16x16x32_bf16 v[228:231], v[160:163], v[132:135], 0
    ds_read_b128 v[220:223], v4 offset:2496
    s_waitcnt lgkmcnt(6)
    v_mfma_f32_16x16x32_bf16 v[232:235], v[176:179], v[128:131], 0
    ds_read_b128 v[248:251], v4 offset:2432
    v_mfma_f32_16x16x32_bf16 v[184:187], v[76:79], v[160:163], v[184:187]
    s_waitcnt lgkmcnt(5)
    v_lshlrev_b32 v180, 16, v182
    v_and_b32 v181, s48, v182
    s_waitcnt lgkmcnt(4)
    v_mfma_f32_16x16x32_bf16 v[252:255], v[216:219], v[136:139], 0
    ds_read_b128 v[240:243], v4 offset:2368
    s_waitcnt lgkmcnt(3)
    v_mfma_f32_16x16x32_bf16 v[148:151], v[188:191], v[140:143], 0
    v_lshlrev_b32 v182, 16, v183
    v_and_b32 v183, s48, v183
    v_mfma_f32_16x16x32_bf16 v[184:187], v[80:83], v[216:219], v[184:187]
    ds_read_b128 v[236:239], v4 offset:2304
    s_waitcnt lgkmcnt(3)
    v_mfma_f32_16x16x32_bf16 v[184:187], v[12:15], v[220:223], v[184:187]
    v_fma_f32 v192, -v196, v192, v244
    v_fma_f32 v193, -v197, v193, v245
    v_mfma_f32_16x16x32_bf16 v[164:167], v[44:47], v[220:223], v[180:183]
    ds_read_b128 v[156:159], v4 offset:2240
    s_waitcnt lgkmcnt(3)
    v_mfma_f32_16x16x32_bf16 v[184:187], v[16:19], v[248:251], v[184:187]
    v_fma_f32 v194, -v198, v194, v246
    v_fma_f32 v195, -v199, v195, v247
    v_mfma_f32_16x16x32_bf16 v[164:167], v[48:51], v[248:251], v[164:167]
    ds_read_b128 v[172:175], v4 offset:2176
    s_waitcnt lgkmcnt(3)
    v_mfma_f32_16x16x32_bf16 v[184:187], v[20:23], v[240:243], v[184:187]
    v_cvt_pk_bf16_f32 v192, v192, v193
    v_cvt_pk_bf16_f32 v193, v194, v195
    v_mfma_f32_16x16x32_bf16 v[164:167], v[52:55], v[240:243], v[164:167]
    ds_read_b64 v[206:207], v5 offset:2048
    s_waitcnt lgkmcnt(3)
    v_mfma_f32_16x16x32_bf16 v[184:187], v[24:27], v[236:239], v[184:187]
    ds_read_b128 v[152:155], v4 offset:2112
    v_mfma_f32_16x16x32_bf16 v[164:167], v[56:59], v[236:239], v[164:167]
    ds_read_b128 v[176:179], v4 offset:2048
    s_waitcnt lgkmcnt(4)
    v_mfma_f32_16x16x32_bf16 v[184:187], v[28:31], v[156:159], v[184:187]
    ds_write_b64 v7, v[192:193] offset:1536
    ds_write_b32 v8, v2 offset:480
    v_mfma_f32_16x16x32_bf16 v[164:167], v[60:63], v[156:159], v[164:167]
    ds_read_b128 v[100:103], v11 offset:0
    s_waitcnt lgkmcnt(6)
    v_mfma_f32_16x16x32_bf16 v[184:187], v[32:35], v[172:175], v[184:187]
    ds_read_b128 v[104:107], v11 offset:1280
    v_mfma_f32_16x16x32_bf16 v[164:167], v[64:67], v[172:175], v[164:167]
    v_cvt_pk_bf16_f32 v160, v168, v212
    v_cvt_pk_bf16_f32 v161, v169, v213
    s_waitcnt lgkmcnt(5)
    v_mfma_f32_16x16x32_bf16 v[184:187], v[36:39], v[152:155], v[184:187]
    v_cvt_pk_bf16_f32 v162, v170, v214
    v_cvt_pk_bf16_f32 v163, v171, v215
    v_mfma_f32_16x16x32_bf16 v[164:167], v[68:71], v[152:155], v[164:167]
    v_cvt_pk_bf16_f32 v188, v228, v232
    v_cvt_pk_bf16_f32 v189, v229, v233
    s_waitcnt lgkmcnt(4)
    v_mfma_f32_16x16x32_bf16 v[184:187], v[40:43], v[176:179], v[184:187]
    v_cvt_pk_bf16_f32 v190, v230, v234
    v_cvt_pk_bf16_f32 v191, v231, v235
    v_mfma_f32_16x16x32_bf16 v[164:167], v[72:75], v[176:179], v[164:167]
    ds_read_b128 v[108:111], v11 offset:2752
    s_waitcnt lgkmcnt(2)
    v_mfma_f32_16x16x32_bf16 v[184:187], v[208:211], v[100:103], v[184:187]
    ds_read_b128 v[216:219], v4 offset:1984
    s_waitcnt lgkmcnt(2)
    v_mfma_f32_16x16x32_bf16 v[184:187], v[224:227], v[104:107], v[184:187]
    ds_read_b128 v[220:223], v6 offset:4096
    v_mfma_f32_16x16x32_bf16 v[184:187], v[200:203], v[92:95], v[184:187]
    v_cvt_pk_bf16_f32 v244, v252, v148
    v_cvt_pk_bf16_f32 v245, v253, v149
    v_mfma_f32_16x16x32_bf16 v[184:187], v[144:147], v[96:99], v[184:187]
    ds_read_b128 v[196:199], v4 offset:1968
    v_mfma_f32_16x16x32_bf16 v[184:187], v[160:163], v[84:87], v[184:187]
    v_cvt_pk_bf16_f32 v246, v254, v150
    v_cvt_pk_bf16_f32 v247, v255, v151
    v_mfma_f32_16x16x32_bf16 v[184:187], v[188:191], v[88:91], v[184:187]
    ds_read_b64 v[250:251], v5 offset:3072
    s_waitcnt lgkmcnt(4)
    v_mfma_f32_16x16x32_bf16 v[184:187], v[244:247], v[108:111], v[184:187]
    ds_read_b128 v[240:243], v4 offset:960
    s_waitcnt lgkmcnt(4)
    v_mfma_f32_16x16x32_bf16 v[236:239], v[216:219], v[124:127], 0
    ds_read_b128 v[192:195], v4 offset:944
    v_mfma_f32_16x16x32_bf16 v[156:159], v[216:219], v[128:131], 0
    ds_read_b128 v[172:175], v4 offset:3008
    v_mfma_f32_16x16x32_bf16 v[168:171], v[216:219], v[132:135], 0
    v_lshlrev_b32 v204, 16, v206
    v_and_b32 v205, s48, v206
    s_waitcnt lgkmcnt(4)
    v_mfma_f32_16x16x32_bf16 v[212:215], v[196:199], v[128:131], 0
    ds_read_b128 v[152:155], v4 offset:2944
    v_mfma_f32_16x16x32_bf16 v[164:167], v[76:79], v[216:219], v[164:167]
    v_lshlrev_b32 v206, 16, v207
    v_and_b32 v207, s48, v207
    s_waitcnt lgkmcnt(3)
    v_mfma_f32_16x16x32_bf16 v[228:231], v[240:243], v[136:139], 0
    ds_read_b128 v[232:235], v4 offset:2880
    s_waitcnt lgkmcnt(3)
    v_mfma_f32_16x16x32_bf16 v[176:179], v[192:195], v[140:143], 0
    v_lshlrev_b32 v248, 16, v250
    v_and_b32 v249, s48, v250
    v_mfma_f32_16x16x32_bf16 v[164:167], v[80:83], v[240:243], v[164:167]
    ds_read_b128 v[208:211], v4 offset:2816
    s_waitcnt lgkmcnt(3)
    v_mfma_f32_16x16x32_bf16 v[164:167], v[12:15], v[172:175], v[164:167]
    v_lshlrev_b32 v250, 16, v251
    v_and_b32 v251, s48, v251
    s_nop 1
    v_mfma_f32_16x16x32_bf16 v[224:227], v[44:47], v[172:175], v[248:251]
    ds_read_b128 v[252:255], v4 offset:2752
    s_waitcnt lgkmcnt(3)
    v_mfma_f32_16x16x32_bf16 v[164:167], v[16:19], v[152:155], v[164:167]
    v_add_f32 v184, v184, v204
    v_add_f32 v185, v185, v205
    v_mfma_f32_16x16x32_bf16 v[224:227], v[48:51], v[152:155], v[224:227]
    ds_read_b128 v[148:151], v4 offset:2688
    s_waitcnt lgkmcnt(3)
    v_mfma_f32_16x16x32_bf16 v[164:167], v[20:23], v[232:235], v[164:167]
    v_add_f32 v186, v186, v206
    v_add_f32 v187, v187, v207
    v_mfma_f32_16x16x32_bf16 v[224:227], v[52:55], v[232:235], v[224:227]
    ds_read_b128 v[196:199], v4 offset:2624
    s_waitcnt lgkmcnt(3)
    v_mfma_f32_16x16x32_bf16 v[164:167], v[24:27], v[208:211], v[164:167]
    v_fma_f32 v184, -v220, v184, v204
    v_fma_f32 v185, -v221, v185, v205
    v_mfma_f32_16x16x32_bf16 v[224:227], v[56:59], v[208:211], v[224:227]
    ds_read_b128 v[216:219], v4 offset:2560
    s_waitcnt lgkmcnt(3)
    v_mfma_f32_16x16x32_bf16 v[164:167], v[28:31], v[252:255], v[164:167]
    v_fma_f32 v186, -v222, v186, v206
    v_fma_f32 v187, -v223, v187, v207
    v_mfma_f32_16x16x32_bf16 v[224:227], v[60:63], v[252:255], v[224:227]
    v_cvt_pk_bf16_f32 v184, v184, v185
    v_cvt_pk_bf16_f32 v185, v186, v187
    s_waitcnt lgkmcnt(2)
    v_mfma_f32_16x16x32_bf16 v[164:167], v[32:35], v[148:151], v[164:167]
    ds_write_b64 v7, v[184:185] offset:2048
    ds_write_b32 v8, v2 offset:512
    v_mfma_f32_16x16x32_bf16 v[224:227], v[64:67], v[148:151], v[224:227]
    v_cvt_pk_bf16_f32 v192, v236, v156
    v_cvt_pk_bf16_f32 v193, v237, v157
    s_waitcnt lgkmcnt(3)
    v_mfma_f32_16x16x32_bf16 v[164:167], v[36:39], v[196:199], v[164:167]
    v_cvt_pk_bf16_f32 v194, v238, v158
    v_cvt_pk_bf16_f32 v195, v239, v159
    v_mfma_f32_16x16x32_bf16 v[224:227], v[68:71], v[196:199], v[224:227]
    v_cvt_pk_bf16_f32 v240, v168, v212
    v_cvt_pk_bf16_f32 v241, v169, v213
    s_waitcnt lgkmcnt(2)
    v_mfma_f32_16x16x32_bf16 v[164:167], v[40:43], v[216:219], v[164:167]
    v_cvt_pk_bf16_f32 v242, v170, v214
    v_cvt_pk_bf16_f32 v243, v171, v215
    v_mfma_f32_16x16x32_bf16 v[224:227], v[72:75], v[216:219], v[224:227]
    ds_read_b128 v[112:115], v11 offset:2688
    v_mfma_f32_16x16x32_bf16 v[164:167], v[200:203], v[100:103], v[164:167]
    v_cvt_pk_bf16_f32 v172, v228, v176
    v_cvt_pk_bf16_f32 v173, v229, v177
    v_mfma_f32_16x16x32_bf16 v[164:167], v[144:147], v[104:107], v[164:167]
    ds_read_b128 v[152:155], v4 offset:2496
    v_mfma_f32_16x16x32_bf16 v[164:167], v[160:163], v[92:95], v[164:167]
    ds_read_b128 v[232:235], v6 offset:5120
    v_mfma_f32_16x16x32_bf16 v[164:167], v[188:191], v[96:99], v[164:167]
    v_cvt_pk_bf16_f32 v174, v230, v178
    v_cvt_pk_bf16_f32 v175, v231, v179
    v_mfma_f32_16x16x32_bf16 v[164:167], v[192:195], v[84:87], v[164:167]
    ds_read_b128 v[208:211], v4 offset:2480
    v_mfma_f32_16x16x32_bf16 v[164:167], v[240:243], v[88:91], v[164:167]
    ds_read_b64 v[206:207], v5 offset:3584
    s_waitcnt lgkmcnt(4)
    v_mfma_f32_16x16x32_bf16 v[164:167], v[244:247], v[112:115], v[164:167]
    ds_read_b128 v[220:223], v4 offset:1472
    v_mfma_f32_16x16x32_bf16 v[164:167], v[172:175], v[108:111], v[164:167]
    ds_read_b128 v[252:255], v4 offset:1456
    s_waitcnt lgkmcnt(5)
    v_mfma_f32_16x16x32_bf16 v[184:187], v[152:155], v[124:127], 0
    ds_read_b128 v[148:151], v4 offset:3520
    v_mfma_f32_16x16x32_bf16 v[236:239], v[152:155], v[128:131], 0
    ds_read_b128 v[156:159], v4 offset:3456
    v_mfma_f32_16x16x32_bf16 v[196:199], v[152:155], v[132:135], 0
    ds_read_b128 v[168:171], v4 offset:3392
    s_waitcnt lgkmcnt(6)
    v_mfma_f32_16x16x32_bf16 v[212:215], v[208:211], v[128:131], 0
    s_waitcnt lgkmcnt(5)
    v_lshlrev_b32 v204, 16, v206
    v_and_b32 v205, s48, v206
    v_mfma_f32_16x16x32_bf16 v[224:227], v[76:79], v[152:155], v[224:227]
    v_lshlrev_b32 v206, 16, v207
    v_and_b32 v207, s48, v207
    s_waitcnt lgkmcnt(4)
    v_mfma_f32_16x16x32_bf16 v[216:219], v[220:223], v[136:139], 0
    v_fma_f32 v164, -v232, v164, v180
    v_fma_f32 v165, -v233, v165, v181
    s_waitcnt lgkmcnt(3)
    v_mfma_f32_16x16x32_bf16 v[200:203], v[252:255], v[140:143], 0
    v_fma_f32 v166, -v234, v166, v182
    v_fma_f32 v167, -v235, v167, v183
    v_mfma_f32_16x16x32_bf16 v[224:227], v[80:83], v[220:223], v[224:227]
    ds_read_b128 v[144:147], v4 offset:3328
    s_waitcnt lgkmcnt(2)
    v_mfma_f32_16x16x32_bf16 v[224:227], v[12:15], v[148:151], v[224:227]
    v_cvt_pk_bf16_f32 v164, v164, v165
    v_cvt_pk_bf16_f32 v165, v166, v167
    v_mfma_f32_16x16x32_bf16 v[228:231], v[44:47], v[148:151], v[204:207]
    ds_read_b128 v[176:179], v4 offset:3264
    v_mfma_f32_16x16x32_bf16 v[224:227], v[16:19], v[156:159], v[224:227]
    ds_write_b64 v7, v[164:165] offset:2560
    ds_write_b32 v8, v2 offset:544
    v_mfma_f32_16x16x32_bf16 v[228:231], v[48:51], v[156:159], v[228:231]
    ds_read_b128 v[208:211], v4 offset:3200
    s_waitcnt lgkmcnt(5)
    v_mfma_f32_16x16x32_bf16 v[224:227], v[20:23], v[168:171], v[224:227]
    v_cvt_pk_bf16_f32 v152, v184, v236
    v_cvt_pk_bf16_f32 v153, v185, v237
    v_mfma_f32_16x16x32_bf16 v[228:231], v[52:55], v[168:171], v[228:231]
    ds_read_b128 v[252:255], v4 offset:3136
    s_waitcnt lgkmcnt(5)
    v_mfma_f32_16x16x32_bf16 v[224:227], v[24:27], v[144:147], v[224:227]
    v_cvt_pk_bf16_f32 v154, v186, v238
    v_cvt_pk_bf16_f32 v155, v187, v239
    v_mfma_f32_16x16x32_bf16 v[228:231], v[56:59], v[144:147], v[228:231]
    ds_read_b128 v[180:183], v4 offset:3072
    s_waitcnt lgkmcnt(5)
    v_mfma_f32_16x16x32_bf16 v[224:227], v[28:31], v[176:179], v[224:227]
    v_cvt_pk_bf16_f32 v232, v196, v212
    v_cvt_pk_bf16_f32 v233, v197, v213
    v_mfma_f32_16x16x32_bf16 v[228:231], v[60:63], v[176:179], v[228:231]
    v_cvt_pk_bf16_f32 v234, v198, v214
    v_cvt_pk_bf16_f32 v235, v199, v215
    s_waitcnt lgkmcnt(2)
    v_mfma_f32_16x16x32_bf16 v[224:227], v[32:35], v[208:211], v[224:227]
    v_cvt_pk_bf16_f32 v220, v216, v200
    v_cvt_pk_bf16_f32 v221, v217, v201
    v_mfma_f32_16x16x32_bf16 v[228:231], v[64:67], v[208:211], v[228:231]
    v_cvt_pk_bf16_f32 v222, v218, v202
    v_cvt_pk_bf16_f32 v223, v219, v203
    s_waitcnt lgkmcnt(1)
    v_mfma_f32_16x16x32_bf16 v[224:227], v[36:39], v[252:255], v[224:227]
    ds_read_b128 v[116:119], v11 offset:2624
    v_mfma_f32_16x16x32_bf16 v[228:231], v[68:71], v[252:255], v[228:231]
    ds_read_b128 v[148:151], v4 offset:3008
    s_waitcnt lgkmcnt(2)
    v_mfma_f32_16x16x32_bf16 v[224:227], v[40:43], v[180:183], v[224:227]
    ds_read_b128 v[164:167], v6 offset:6144
    v_mfma_f32_16x16x32_bf16 v[228:231], v[72:75], v[180:183], v[228:231]
    ds_read_b128 v[156:159], v4 offset:2992
    v_mfma_f32_16x16x32_bf16 v[224:227], v[160:163], v[100:103], v[224:227]
    ds_read_b128 v[168:171], v4 offset:1984
    v_mfma_f32_16x16x32_bf16 v[224:227], v[188:191], v[104:107], v[224:227]
    ds_read_b128 v[184:187], v4 offset:1968
    v_mfma_f32_16x16x32_bf16 v[224:227], v[192:195], v[92:95], v[224:227]
    ds_read_b128 v[236:239], v4 offset:4032
    v_mfma_f32_16x16x32_bf16 v[224:227], v[240:243], v[96:99], v[224:227]
    ds_read_b128 v[144:147], v4 offset:3968
    v_mfma_f32_16x16x32_bf16 v[224:227], v[152:155], v[84:87], v[224:227]
    ds_read_b128 v[176:179], v4 offset:3904
    v_mfma_f32_16x16x32_bf16 v[224:227], v[232:235], v[88:91], v[224:227]
    ds_read_b128 v[196:199], v4 offset:3840
    s_waitcnt lgkmcnt(6)
    v_mfma_f32_16x16x32_bf16 v[224:227], v[244:247], v[116:119], v[224:227]
    ds_read_b128 v[212:215], v4 offset:3776
    v_mfma_f32_16x16x32_bf16 v[224:227], v[172:175], v[112:115], v[224:227]
    ds_read_b128 v[208:211], v4 offset:3712
    v_mfma_f32_16x16x32_bf16 v[224:227], v[220:223], v[108:111], v[224:227]
    ds_read_b128 v[216:219], v4 offset:3648
    v_mfma_f32_16x16x32_bf16 v[200:203], v[148:151], v[124:127], 0
    ds_read_b128 v[252:255], v4 offset:3584
    v_mfma_f32_16x16x32_bf16 v[180:183], v[148:151], v[128:131], 0
    v_mfma_f32_16x16x32_bf16 v[160:163], v[148:151], v[132:135], 0
    v_mfma_f32_16x16x32_bf16 v[188:191], v[156:159], v[128:131], 0
    v_mfma_f32_16x16x32_bf16 v[228:231], v[76:79], v[148:151], v[228:231]
    s_nop 0
    v_fma_f32 v224, -v164, v224, v248
    v_fma_f32 v225, -v165, v225, v249
    s_waitcnt lgkmcnt(2)
    v_mfma_f32_16x16x32_bf16 v[156:159], v[168:171], v[136:139], 0
    v_fma_f32 v226, -v166, v226, v250
    v_fma_f32 v227, -v167, v227, v251
    v_mfma_f32_16x16x32_bf16 v[148:151], v[184:187], v[140:143], 0
    v_cvt_pk_bf16_f32 v224, v224, v225
    v_cvt_pk_bf16_f32 v225, v226, v227
    v_mfma_f32_16x16x32_bf16 v[228:231], v[80:83], v[168:171], v[228:231]
    ds_write_b64 v7, v[224:225] offset:3072
    ds_write_b32 v8, v2 offset:576
    v_mfma_f32_16x16x32_bf16 v[228:231], v[12:15], v[236:239], v[228:231]
    v_cvt_pk_bf16_f32 v248, v200, v180
    v_cvt_pk_bf16_f32 v249, v201, v181
    v_mfma_f32_16x16x32_bf16 v[228:231], v[16:19], v[144:147], v[228:231]
    v_cvt_pk_bf16_f32 v250, v202, v182
    v_cvt_pk_bf16_f32 v251, v203, v183
    v_mfma_f32_16x16x32_bf16 v[228:231], v[20:23], v[176:179], v[228:231]
    v_cvt_pk_bf16_f32 v164, v160, v188
    v_cvt_pk_bf16_f32 v165, v161, v189
    v_mfma_f32_16x16x32_bf16 v[228:231], v[24:27], v[196:199], v[228:231]
    v_cvt_pk_bf16_f32 v166, v162, v190
    v_cvt_pk_bf16_f32 v167, v163, v191
    v_mfma_f32_16x16x32_bf16 v[228:231], v[28:31], v[212:215], v[228:231]
    v_cvt_pk_bf16_f32 v184, v156, v148
    v_cvt_pk_bf16_f32 v185, v157, v149
    v_mfma_f32_16x16x32_bf16 v[228:231], v[32:35], v[208:211], v[228:231]
    v_cvt_pk_bf16_f32 v186, v158, v150
    v_cvt_pk_bf16_f32 v187, v159, v151
    s_waitcnt lgkmcnt(2)
    v_mfma_f32_16x16x32_bf16 v[228:231], v[36:39], v[216:219], v[228:231]
    ds_read_b128 v[120:123], v11 offset:2560
    v_mfma_f32_16x16x32_bf16 v[228:231], v[40:43], v[252:255], v[228:231]
    ds_read_b128 v[168:171], v6 offset:7168
    v_mfma_f32_16x16x32_bf16 v[228:231], v[192:195], v[100:103], v[228:231]
    v_mfma_f32_16x16x32_bf16 v[228:231], v[240:243], v[104:107], v[228:231]
    v_mfma_f32_16x16x32_bf16 v[228:231], v[152:155], v[92:95], v[228:231]
    v_mfma_f32_16x16x32_bf16 v[228:231], v[232:235], v[96:99], v[228:231]
    v_mfma_f32_16x16x32_bf16 v[228:231], v[248:251], v[84:87], v[228:231]
    v_mfma_f32_16x16x32_bf16 v[228:231], v[164:167], v[88:91], v[228:231]
    s_waitcnt lgkmcnt(0)
    v_mfma_f32_16x16x32_bf16 v[228:231], v[244:247], v[120:123], v[228:231]
    v_mfma_f32_16x16x32_bf16 v[228:231], v[172:175], v[116:119], v[228:231]
    v_mfma_f32_16x16x32_bf16 v[228:231], v[220:223], v[112:115], v[228:231]
    v_mfma_f32_16x16x32_bf16 v[228:231], v[184:187], v[108:111], v[228:231]
    s_nop 7
    v_fma_f32 v228, -v168, v228, v204
    v_fma_f32 v229, -v169, v229, v205
    v_fma_f32 v230, -v170, v230, v206
    v_fma_f32 v231, -v171, v231, v207
    v_cvt_pk_bf16_f32 v228, v228, v229
    v_cvt_pk_bf16_f32 v229, v230, v231
    ds_write_b64 v7, v[228:229] offset:3584
    ds_write_b32 v8, v2 offset:608
    s_cmp_ge_u32 s3, 4
    s_cbranch_scc1 L_EEND
    s_setprio 2
    ds_read_b32 v49, v3 offset:32
    v_and_b32 v12, 7, v1
    v_lshlrev_b32 v12, 2, v12
    v_lshrrev_b32 v11, 4, v1
    s_cmp_lt_u32 s38, 2
    s_cbranch_scc1 L_FX
    v_bfe_u32 v10, v1, 2, 2
    v_and_b32 v50, 3, v1
    v_lshlrev_b32 v51, 5, v11
    v_lshl_add_u32 v51, v50, 3, v51
    v_mul_u32_u24 v54, 8768, v10
    s_and_b32 s42, s38, 1
    s_lshl_b32 s41, s42, 8
    s_add_u32 s41, s41, 1024
    v_add3_u32 v54, v54, v51, s41
    s_lshl_b32 s42, s42, 7
    v_add_u32 v55, s42, v1
    v_lshlrev_b32 v58, 11, v55
    s_lshl_b32 s41, s39, 4
    v_add_u32 v58, s41, v58
    s_brev_b32 s50, 1
    s_waitcnt lgkmcnt(0)
    s_mov_b32 s62, 0
T_75:
    ds_read_b32 v10, v12 offset:384
    ds_read_u8 v60, v55 offset:640
    ds_read_u8 v61, v55 offset:704
    s_add_u32 s62, s62, 1
    s_waitcnt lgkmcnt(0)
    v_cmp_eq_u32 vcc, 0, v10
    s_cbranch_vccz TD_76
    s_sleep 1
    s_cmp_lt_u32 s62, 2097152
    s_cbranch_scc1 T_75
TD_76:
    v_lshlrev_b32 v112, 31, v60
    v_and_or_b32 v112, v112, s50, v58
    v_lshlrev_b32 v113, 31, v61
    v_and_or_b32 v113, v113, s50, v58
    ds_read_b64_tr_b16 v[96:97], v54 offset:0
    ds_read_b64_tr_b16 v[98:99], v54 offset:35072
    ds_read_b64_tr_b16 v[100:101], v54 offset:128
    ds_read_b64_tr_b16 v[102:103], v54 offset:35200
    s_waitcnt lgkmcnt(2)
    s_waitcnt vmcnt(2)
    s_mov_b32 s41, 0
    buffer_store_dwordx4 v[96:99], v112, s[12:15], s41 offen
    s_waitcnt lgkmcnt(0)
    s_waitcnt vmcnt(2)
    s_mov_b32 s41, 131072
    buffer_store_dwordx4 v[100:103], v113, s[12:15], s41 offen
    v_lshlrev_b32 v144, 30, v60
    v_and_or_b32 v144, v144, s50, v58
    v_lshlrev_b32 v145, 30, v61
    v_and_or_b32 v145, v145, s50, v58
    s_mov_b32 s62, 0
T_77:
    ds_read_b32 v10, v12 offset:416
    s_add_u32 s62, s62, 1
    s_waitcnt lgkmcnt(0)
    v_cmp_eq_u32 vcc, 0, v10
    s_cbranch_vccz TD_78
    s_sleep 2
    s_cmp_lt_u32 s62, 2097152
    s_cbranch_scc1 T_77
TD_78:
    ds_read_b64_tr_b16 v[128:129], v54 offset:512
    ds_read_b64_tr_b16 v[130:131], v54 offset:35584
    ds_read_b64_tr_b16 v[132:133], v54 offset:640
    ds_read_b64_tr_b16 v[134:135], v54 offset:35712
    s_waitcnt lgkmcnt(2)
    s_waitcnt vmcnt(2)
    s_mov_b32 s41, 524288
    buffer_store_dwordx4 v[128:131], v144, s[12:15], s41 offen
    s_waitcnt lgkmcnt(0)
    s_waitcnt vmcnt(2)
    s_mov_b32 s41, 655360
    buffer_store_dwordx4 v[132:135], v145, s[12:15], s41 offen
    v_lshlrev_b32 v112, 29, v60
    v_and_or_b32 v112, v112, s50, v58
    v_lshlrev_b32 v113, 29, v61
    v_and_or_b32 v113, v113, s50, v58
    s_mov_b32 s62, 0
T_79:
    ds_read_b32 v10, v12 offset:448
    s_add_u32 s62, s62, 1
    s_waitcnt lgkmcnt(0)
    v_cmp_eq_u32 vcc, 0, v10
    s_cbranch_vccz TD_80
    s_sleep 2
    s_cmp_lt_u32 s62, 2097152
    s_cbranch_scc1 T_79
TD_80:
    ds_read_b64_tr_b16 v[96:97], v54 offset:1024
    ds_read_b64_tr_b16 v[98:99], v54 offset:36096
    ds_read_b64_tr_b16 v[100:101], v54 offset:1152
    ds_read_b64_tr_b16 v[102:103], v54 offset:36224
    s_waitcnt lgkmcnt(2)
    s_waitcnt vmcnt(2)
    s_mov_b32 s41, 1048576
    buffer_store_dwordx4 v[96:99], v112, s[12:15], s41 offen
    s_waitcnt lgkmcnt(0)
    s_waitcnt vmcnt(2)
    s_mov_b32 s41, 1179648
    buffer_store_dwordx4 v[100:103], v113, s[12:15], s41 offen
    v_lshlrev_b32 v144, 28, v60
    v_and_or_b32 v144, v144, s50, v58
    v_lshlrev_b32 v145, 28, v61
    v_and_or_b32 v145, v145, s50, v58
    s_mov_b32 s62, 0
T_81:
    ds_read_b32 v10, v12 offset:480
    s_add_u32 s62, s62, 1
    s_waitcnt lgkmcnt(0)
    v_cmp_eq_u32 vcc, 0, v10
    s_cbranch_vccz TD_82
    s_sleep 2
    s_cmp_lt_u32 s62, 2097152
    s_cbranch_scc1 T_81
TD_82:
    ds_read_b64_tr_b16 v[128:129], v54 offset:1536
    ds_read_b64_tr_b16 v[130:131], v54 offset:36608
    ds_read_b64_tr_b16 v[132:133], v54 offset:1664
    ds_read_b64_tr_b16 v[134:135], v54 offset:36736
    s_waitcnt lgkmcnt(2)
    s_waitcnt vmcnt(2)
    s_mov_b32 s41, 1572864
    buffer_store_dwordx4 v[128:131], v144, s[12:15], s41 offen
    s_waitcnt lgkmcnt(0)
    s_waitcnt vmcnt(2)
    s_mov_b32 s41, 1703936
    buffer_store_dwordx4 v[132:135], v145, s[12:15], s41 offen
    v_lshlrev_b32 v112, 27, v60
    v_and_or_b32 v112, v112, s50, v58
    v_lshlrev_b32 v113, 27, v61
    v_and_or_b32 v113, v113, s50, v58
    s_mov_b32 s62, 0
T_83:
    ds_read_b32 v10, v12 offset:512
    s_add_u32 s62, s62, 1
    s_waitcnt lgkmcnt(0)
    v_cmp_eq_u32 vcc, 0, v10
    s_cbranch_vccz TD_84
    s_sleep 2
    s_cmp_lt_u32 s62, 2097152
    s_cbranch_scc1 T_83
TD_84:
    ds_read_b64_tr_b16 v[96:97], v54 offset:2048
    ds_read_b64_tr_b16 v[98:99], v54 offset:37120
    ds_read_b64_tr_b16 v[100:101], v54 offset:2176
    ds_read_b64_tr_b16 v[102:103], v54 offset:37248
    s_waitcnt lgkmcnt(2)
    s_waitcnt vmcnt(2)
    s_mov_b32 s41, 2097152
    buffer_store_dwordx4 v[96:99], v112, s[12:15], s41 offen
    s_waitcnt lgkmcnt(0)
    s_waitcnt vmcnt(2)
    s_mov_b32 s41, 2228224
    buffer_store_dwordx4 v[100:103], v113, s[12:15], s41 offen
    v_lshlrev_b32 v144, 26, v60
    v_and_or_b32 v144, v144, s50, v58
    v_lshlrev_b32 v145, 26, v61
    v_and_or_b32 v145, v145, s50, v58
    s_mov_b32 s62, 0
T_85:
    ds_read_b32 v10, v12 offset:544
    s_add_u32 s62, s62, 1
    s_waitcnt lgkmcnt(0)
    v_cmp_eq_u32 vcc, 0, v10
    s_cbranch_vccz TD_86
    s_sleep 2
    s_cmp_lt_u32 s62, 2097152
    s_cbranch_scc1 T_85
TD_86:
    ds_read_b64_tr_b16 v[128:129], v54 offset:2560
    ds_read_b64_tr_b16 v[130:131], v54 offset:37632
    ds_read_b64_tr_b16 v[132:133], v54 offset:2688
    ds_read_b64_tr_b16 v[134:135], v54 offset:37760
    s_waitcnt lgkmcnt(2)
    s_waitcnt vmcnt(2)
    s_mov_b32 s41, 2621440
    buffer_store_dwordx4 v[128:131], v144, s[12:15], s41 offen
    s_waitcnt lgkmcnt(0)
    s_waitcnt vmcnt(2)
    s_mov_b32 s41, 2752512
    buffer_store_dwordx4 v[132:135], v145, s[12:15], s41 offen
    v_lshlrev_b32 v112, 25, v60
    v_and_or_b32 v112, v112, s50, v58
    v_lshlrev_b32 v113, 25, v61
    v_and_or_b32 v113, v113, s50, v58
    s_mov_b32 s62, 0
T_87:
    ds_read_b32 v10, v12 offset:576
    s_add_u32 s62, s62, 1
    s_waitcnt lgkmcnt(0)
    v_cmp_eq_u32 vcc, 0, v10
    s_cbranch_vccz TD_88
    s_sleep 2
    s_cmp_lt_u32 s62, 2097152
    s_cbranch_scc1 T_87
TD_88:
    ds_read_b64_tr_b16 v[96:97], v54 offset:3072
    ds_read_b64_tr_b16 v[98:99], v54 offset:38144
    ds_read_b64_tr_b16 v[100:101], v54 offset:3200
    ds_read_b64_tr_b16 v[102:103], v54 offset:38272
    s_waitcnt lgkmcnt(2)
    s_waitcnt vmcnt(2)
    s_mov_b32 s41, 3145728
    buffer_store_dwordx4 v[96:99], v112, s[12:15], s41 offen
    s_waitcnt lgkmcnt(0)
    s_waitcnt vmcnt(2)
    s_mov_b32 s41, 3276800
    buffer_store_dwordx4 v[100:103], v113, s[12:15], s41 offen
    v_lshlrev_b32 v144, 24, v60
    v_and_or_b32 v144, v144, s50, v58
    v_lshlrev_b32 v145, 24, v61
    v_and_or_b32 v145, v145, s50, v58
    s_mov_b32 s62, 0
T_89:
    ds_read_b32 v10, v12 offset:608
    ds_read_b64_tr_b16 v[128:129], v54 offset:3584
    ds_read_b64_tr_b16 v[130:131], v54 offset:38656
    ds_read_b64_tr_b16 v[132:133], v54 offset:3712
    ds_read_b64_tr_b16 v[134:135], v54 offset:38784
    s_add_u32 s62, s62, 1
    s_waitcnt lgkmcnt(0)
    v_cmp_eq_u32 vcc, 0, v10
    s_cbranch_vccz TD_90
    s_sleep 1
    s_cmp_lt_u32 s62, 2097152
    s_cbranch_scc1 T_89
TD_90:
    s_waitcnt vmcnt(2)
    s_mov_b32 s41, 3670016
    buffer_store_dwordx4 v[128:131], v144, s[12:15], s41 offen
    s_waitcnt vmcnt(2)
    s_mov_b32 s41, 3801088
    buffer_store_dwordx4 v[132:135], v145, s[12:15], s41 offen
    s_branch L_EEND
L_FX:
    v_lshlrev_b32 v8, 4, v1
    v_lshrrev_b32 v17, 1, v11
    v_and_b32 v18, 1, v11
    v_lshl_or_b32 v17, v18, 1, v17
    s_lshl_b32 s41, s38, 2
    v_add_u32 v17, s41, v17
    s_lshl_b32 s44, s39, 1
    s_add_u32 s44, s44, s38
    s_mul_i32 s44, s44, 8320
    s_add_u32 s44, s44, 1048576
    s_add_u32 s45, s44, 4096
    s_mov_b32 s46, 0x0c04000c
    s_mov_b32 s47, 0x04020100
    s_mov_b32 s42, 0x00ff00ff
    s_mov_b32 s43, 0x00ff00ff
    s_lshl_b32 s32, s39, 9
    s_lshl_b32 s41, s38, 8
    s_add_u32 s32, s32, s41
    s_add_u32 s32, s32, 589824
    s_add_u32 s33, s32, 128
    s_waitcnt lgkmcnt(0)
    v_readfirstlane_b32 s34, v49
    v_readfirstlane_b32 s35, v49
    s_mov_b32 s62, 0
T_91:
    ds_read_b32 v10, v12 offset:384
    ds_read_b32 v34, v12 offset:256
    s_add_u32 s62, s62, 1
    s_waitcnt lgkmcnt(0)
    v_cmp_eq_u32 vcc, 0, v10
    s_cbranch_vccz TD_92
    s_sleep 4
    s_cmp_lt_u32 s62, 2097152
    s_cbranch_scc1 T_91
TD_92:
    v_and_b32 v21, 2047, v34
    v_lshlrev_b32 v22, 2, v21
    v_add_u32 v22, 141312, v22
    ds_read_b32 v6, v22
    v_ashrrev_i32 v22, 31, v34
    v_not_b32 v22, v22
    v_or_b32 v22, 0x80000000, v22
    v_xor_b32 v20, v34, v22
    v_and_b32 v20, s48, v20
    v_mul_f32 v20, 0xbfb8aa3b, v20
    v_exp_f32 v20, v20
    v_mul_u32_u24 v23, 8768, v17
    v_add_f32 v20, 1.0, v20
    v_rcp_f32 v20, v20
    v_lshl_add_u32 v23, v21, 1, v23
    v_lshlrev_b32 v21, 11, v21
    v_lshl_add_u32 v21, v17, 1, v21
    s_lshl_b32 s41, s39, 4
    v_add_u32 v21, s41, v21
    v_mov_b32 v4, 0
    s_waitcnt lgkmcnt(0)
    v_fma_f32 v20, -v6, v20, v20
    s_mov_b32 s62, 0
T_93:
    ds_read_b32 v10, v12 offset:544
    s_add_u32 s62, s62, 1
    s_waitcnt lgkmcnt(0)
    v_cmp_eq_u32 vcc, 0, v10
    s_cbranch_vccz TD_94
    s_sleep 4
    s_cmp_lt_u32 s62, 2097152
    s_cbranch_scc1 T_93
TD_94:
    s_mov_b32 s36, 0
FP_95:
    s_load_dwordx16 s[16:31], s[8:9], s32 glc
    s_add_u32 s36, s36, 1
    s_waitcnt lgkmcnt(0)
    s_cmp_lg_u64 s[16:17], s[34:35]
    s_cbranch_scc1 FN_96
    s_cmp_lg_u64 s[18:19], s[34:35]
    s_cbranch_scc1 FN_96
    s_cmp_lg_u64 s[20:21], s[34:35]
    s_cbranch_scc1 FN_96
    s_cmp_lg_u64 s[22:23], s[34:35]
    s_cbranch_scc1 FN_96
    s_cmp_lg_u64 s[24:25], s[34:35]
    s_cbranch_scc1 FN_96
    s_cmp_lg_u64 s[26:27], s[34:35]
    s_cbranch_scc1 FN_96
    s_cmp_eq_u64 s[28:29], s[34:35]
    s_cbranch_scc1 FD_97
FN_96:
    s_cmp_lt_u32 s36, 131072
    s_cbranch_scc1 FP_95
FD_97:
    buffer_load_dwordx4 v[64:67], v8, s[8:11], s44 offen offset:0 sc1
    buffer_load_dwordx4 v[68:71], v8, s[8:11], s44 offen offset:1024 sc1
    buffer_load_dwordx4 v[72:75], v8, s[8:11], s44 offen offset:2048 sc1
    buffer_load_dwordx4 v[76:79], v8, s[8:11], s44 offen offset:3072 sc1
    buffer_load_dwordx4 v[80:83], v8, s[8:11], s45 offen offset:0 sc1
    buffer_load_dwordx4 v[84:87], v8, s[8:11], s45 offen offset:1024 sc1
    buffer_load_dwordx4 v[88:91], v8, s[8:11], s45 offen offset:2048 sc1
    s_mov_b32 s63, 0
    s_branch L_H3C
L_H3:
    s_mov_b64 exec, s[16:17]
    s_cbranch_execz L_H3S0
    buffer_load_dwordx4 v[64:67], v8, s[8:11], s44 offen offset:0 sc1
L_H3S0:
    s_mov_b64 exec, s[18:19]
    s_cbranch_execz L_H3S1
    buffer_load_dwordx4 v[68:71], v8, s[8:11], s44 offen offset:1024 sc1
L_H3S1:
    s_mov_b64 exec, s[20:21]
    s_cbranch_execz L_H3S2
    buffer_load_dwordx4 v[72:75], v8, s[8:11], s44 offen offset:2048 sc1
L_H3S2:
    s_mov_b64 exec, s[22:23]
    s_cbranch_execz L_H3S3
    buffer_load_dwordx4 v[76:79], v8, s[8:11], s44 offen offset:3072 sc1
L_H3S3:
    s_mov_b64 exec, s[24:25]
    s_cbranch_execz L_H3S4
    buffer_load_dwordx4 v[80:83], v8, s[8:11], s45 offen offset:0 sc1
L_H3S4:
    s_mov_b64 exec, s[26:27]
    s_cbranch_execz L_H3S5
    buffer_load_dwordx4 v[84:87], v8, s[8:11], s45 offen offset:1024 sc1
L_H3S5:
    s_mov_b64 exec, s[28:29]
    s_cbranch_execz L_H3S6
    buffer_load_dwordx4 v[88:91], v8, s[8:11], s45 offen offset:2048 sc1
L_H3S6:
    s_mov_b64 exec, -1
    s_waitcnt vmcnt(0)
L_H3C:
    s_add_u32 s63, s63, 1
    s_waitcnt vmcnt(6)
    v_cmp_ne_u32 s[16:17], v67, v49
    v_perm_b32 v128, v65, v64, s46
    v_perm_b32 v139, v66, v128, s47
    s_waitcnt vmcnt(5)
    v_cmp_ne_u32 s[18:19], v71, v49
    v_perm_b32 v128, v69, v68, s46
    v_perm_b32 v128, v70, v128, s47
    v_add_f32 v136, v64, v68
    v_add_f32 v137, v65, v69
    v_add_f32 v138, v66, v70
    v_add_f32 v139, v139, v128
    s_waitcnt vmcnt(4)
    v_cmp_ne_u32 s[20:21], v75, v49
    v_perm_b32 v128, v73, v72, s46
    v_perm_b32 v128, v74, v128, s47
    v_add_f32 v136, v136, v72
    v_add_f32 v137, v137, v73
    v_add_f32 v138, v138, v74
    v_add_f32 v139, v139, v128
    s_waitcnt vmcnt(3)
    v_cmp_ne_u32 s[22:23], v79, v49
    v_perm_b32 v128, v77, v76, s46
    v_perm_b32 v128, v78, v128, s47
    v_add_f32 v136, v136, v76
    v_add_f32 v137, v137, v77
    v_add_f32 v138, v138, v78
    v_add_f32 v139, v139, v128
    s_waitcnt vmcnt(2)
    v_cmp_ne_u32 s[24:25], v83, v49
    v_perm_b32 v128, v81, v80, s46
    v_perm_b32 v128, v82, v128, s47
    v_add_f32 v136, v136, v80
    v_add_f32 v137, v137, v81
    v_add_f32 v138, v138, v82
    v_add_f32 v139, v139, v128
    s_waitcnt vmcnt(1)
    v_cmp_ne_u32 s[26:27], v87, v49
    v_perm_b32 v128, v85, v84, s46
    v_perm_b32 v128, v86, v128, s47
    v_add_f32 v136, v136, v84
    v_add_f32 v137, v137, v85
    v_add_f32 v138, v138, v86
    v_add_f32 v139, v139, v128
    s_waitcnt vmcnt(0)
    v_cmp_ne_u32 s[28:29], v91, v49
    v_perm_b32 v128, v89, v88, s46
    v_perm_b32 v128, v90, v128, s47
    v_add_f32 v136, v136, v88
    v_add_f32 v137, v137, v89
    v_add_f32 v138, v138, v90
    v_add_f32 v139, v139, v128
    s_or_b64 s[30:31], s[16:17], s[18:19]
    s_or_b64 s[30:31], s[30:31], s[20:21]
    s_or_b64 s[30:31], s[30:31], s[22:23]
    s_or_b64 s[30:31], s[30:31], s[24:25]
    s_or_b64 s[30:31], s[30:31], s[26:27]
    s_or_b64 s[30:31], s[30:31], s[28:29]
    s_cbranch_scc0 L_H3D
    s_cmp_lt_u32 s63, 32768
    s_cbranch_scc1 L_H3
L_H3D:
    v_permlane32_swap_b32 v136, v137
    v_permlane32_swap_b32 v138, v139
    v_add_f32 v136, v136, v137
    v_add_f32 v138, v138, v139
    s_nop 1
    v_permlane16_swap_b32 v136, v138
    v_add_f32 v136, v136, v138
    s_nop 1
    v_add_f32_dpp v136, v136, v136 row_ror:8 row_mask:0xf bank_mask:0xf
    s_mov_b32 s62, 0
T_98:
    ds_read_b32 v10, v12 offset:608
    ds_read_u16_d16_hi v4, v23 offset:1024
    s_add_u32 s62, s62, 1
    s_waitcnt lgkmcnt(0)
    v_cmp_eq_u32 vcc, 0, v10
    s_cbranch_vccz TD_99
    s_sleep 1
    s_cmp_lt_u32 s62, 2097152
    s_cbranch_scc1 T_98
TD_99:
    v_fma_f32 v4, v136, v20, v4
    v_cvt_pk_bf16_f32 v4, v4, v4
    s_mov_b64 exec, s[42:43]
    buffer_store_short v4, v21, s[12:15], 0 offen
L_EEND:
L_END:
    s_endpgm

.section .rodata,"a"
.p2align 6
.amdhsa_kernel gated_mix__ssm_conv_s4d__moe_arch_mod__prompt_kernel
  .amdhsa_next_free_vgpr 256
  .amdhsa_next_free_sgpr 102
  .amdhsa_accum_offset 256
  .amdhsa_group_segment_fixed_size 0
  .amdhsa_kernarg_size 128
  .amdhsa_user_sgpr_count 2
  .amdhsa_user_sgpr_kernarg_segment_ptr 1
  .amdhsa_system_sgpr_workgroup_id_x 1
.end_amdhsa_kernel
```
